```python
import torch

def _softmax(x, axis=-1):
    return torch.softmax(x, dim=axis)
def _gelu(x):
    return torch.nn.functional.gelu(x, approximate="tanh")
def _silu(x):
    return torch.nn.functional.silu(x)
def _sigmoid(x):
    return torch.sigmoid(x)
def _layernorm(x, axis=-1, eps=1e-5):
    m = x.mean(dim=axis, keepdim=True)
    v = x.var(dim=axis, keepdim=True, unbiased=False)
    return (x - m) / torch.sqrt(v + eps)
def _scatter_add(tgt, idx, src, axis=0):
    return tgt.clone().index_add_(axis, idx, src)
def _segment_sum(src, seg, n):
    out = torch.zeros((n,) + src.shape[1:], dtype=src.dtype)
    return out.index_add_(0, seg, src)
def _pad(x, pw):
    flat = tuple(v for pair in reversed(pw) for v in pair)
    return torch.nn.functional.pad(x, flat)

kernel_name = 'sequential_preLN__sliding_block_cached__mixer_token_mlp__decode'

def setup_inputs():

    _w = (lambda a: (lambda t: t.to(torch.bfloat16) if t.is_floating_point() else t)(torch.as_tensor(a)))
    def _A_setup():
        B, Sq, D = 4, 1, 512
        Hq, Hkv, Sk, Dh = 32, 8, 8192, 128
        assert Hq % Hkv == 0, (Hq, Hkv)
        return {
            "x": _w((lambda *s: torch.randn(*s, dtype=torch.bfloat16) * 0.05)(B, Sq, D)),
            "k_cache": _w((lambda *s: torch.randn(*s, dtype=torch.bfloat16) * 3.2)(B, Hkv, Sk, Dh)),
            "v_cache": _w((lambda *s: torch.randn(*s, dtype=torch.bfloat16) * 0.8)(B, Hkv, Sk, Dh)),
            "wq": _w((lambda *s: torch.randn(*s, dtype=torch.bfloat16) * 3.2)(D, Hq * Dh) * (D ** -0.5)),
            "wo": _w((lambda *s: torch.randn(*s, dtype=torch.bfloat16) * 0.8)(Hq * Dh, D) * ((Hq * Dh) ** -0.5)),
        }
    _A_in = _A_setup()

    def _B_setup():
        B, S, D, F = 4, 1, 512, 1792
        return {
            "x": _w((lambda *s: torch.randn(*s, dtype=torch.bfloat16) * 0.05)(B, S, D)),
            "w1": _w((lambda *s: torch.randn(*s, dtype=torch.bfloat16) * 1.6)(S, F) * (S ** -0.5)),
            "b1": _w((lambda *s: torch.randn(*s, dtype=torch.bfloat16) * 1.6)(F) * 0.02),
            "w2": _w((lambda *s: torch.randn(*s, dtype=torch.bfloat16) * 1.6)(F, S) * (F ** -0.5)),
            "b2": _w((lambda *s: torch.randn(*s, dtype=torch.bfloat16) * 0.8)(S) * 0.02),
        }
    _B_in = _B_setup()

    return {
        "A_x": _A_in["x"],
        "A_k_cache": _A_in["k_cache"],
        "A_v_cache": _A_in["v_cache"],
        "A_wq": _A_in["wq"],
        "A_wo": _A_in["wo"],
        "B_x": _B_in["x"],
        "B_w1": _B_in["w1"],
        "B_b1": _B_in["b1"],
        "B_w2": _B_in["w2"],
        "B_b2": _B_in["b2"],
    }

def reference(A_x, A_k_cache, A_v_cache, A_wq, A_wo, B_x, B_w1, B_b1, B_w2, B_b2):
    def _A_ref(x, k_cache, v_cache, wq, wo):
        B, Sq, D = x.shape
        Hq, Dh = 32, 128
        Hkv, Sk = k_cache.shape[1], k_cache.shape[2]
        W = min(4096, max(256, Sk // 4))
        rep = Hq // Hkv
        q = (lambda x, *d: x.permute(*d))((x @ wq).reshape(B, Sq, Hq, Dh), 0, 2, 1, 3)
        k = (lambda x, n, axis: torch.repeat_interleave(x, n, dim=axis))(k_cache[:, :, Sk - W:, :], rep, axis=1)
        v = (lambda x, n, axis: torch.repeat_interleave(x, n, dim=axis))(v_cache[:, :, Sk - W:, :], rep, axis=1)
        scores = torch.einsum("bhqd,bhkd->bhqk", q, k) * (Dh ** -0.5)
        p = _softmax(scores, axis=-1)
        o = torch.einsum("bhqk,bhkd->bhqd", p, v)
        return (lambda x, *d: x.permute(*d))(o, 0, 2, 1, 3).reshape(B, Sq, Hq * Dh) @ wo

    def _B_ref(x, w1, b1, w2, b2):
        B, S, D = x.shape
        h = _layernorm(x, axis=-1)
        u = torch.einsum("bsd,sf->bdf", h, w1) + b1
        u = _gelu(u)
        y = torch.einsum("bdf,fs->bds", u, w2) + b2
        return (lambda x, *d: x.permute(*d))(y, 0, 2, 1)

    x = A_x
    h = x + _A_ref(_layernorm(x, axis=-1), A_k_cache, A_v_cache, A_wq, A_wo)
    h2 = h + _B_ref(_layernorm(h, axis=-1), B_w1, B_b1, B_w2, B_b2)
    return h2
```

```asm
; @launch grid=(256,1,1) block=(896,1,1) lds=155648
.amdgcn_target "amdgcn-amd-amdhsa--gfx950"
.text
.globl sequential_preLN__sliding_block_cached__mixer_token_mlp__decode_kernel
.p2align 8
.type sequential_preLN__sliding_block_cached__mixer_token_mlp__decode_kernel,@function
sequential_preLN__sliding_block_cached__mixer_token_mlp__decode_kernel:
    s_cmp_ge_u32 s2, 256
    s_cbranch_scc1 L_end
    s_load_dwordx16 s[16:31], s[0:1], 0
    s_load_dwordx8 s[32:39], s[0:1], 64
    s_load_dwordx2 s[40:41], s[0:1], 96
    v_lshrrev_b32 v1, 6, v0
    v_and_b32 v0, 63, v0
    v_readfirstlane_b32 s3, v1
    v_mov_b32 v2, 131072
    v_lshl_add_u32 v3, v0, 2, v2
    v_mov_b32 v4, 0
    ds_write_b32 v3, v4 offset:5120
    s_and_b32 s4, s2, 7
    s_lshr_b32 s5, s2, 3
    s_and_b32 s6, s5, 3
    s_lshr_b32 s7, s5, 2
    s_lshl_b32 s8, s6, 3
    s_add_u32 s8, s8, s4
    s_cmp_lt_u32 s5, 16
    s_cselect_b32 s42, 32, 0
    s_waitcnt lgkmcnt(0)
    s_barrier
    s_load_dwordx2 s[62:63], s[40:41], 0
    s_mov_b32 s44, s40
    s_and_b32 s45, s41, 0xffff
    s_mov_b32 s46, 8388608
    s_mov_b32 s47, 0x20000
    s_cmp_eq_u32 s3, 0
    s_cbranch_scc1 L_roleL
    v_lshlrev_b32 v4, 4, v0
    s_cmp_eq_u32 s3, 1
    s_cbranch_scc1 L_earlyQ
    s_cmp_eq_u32 s3, 10
    s_cbranch_scc1 L_earlyT
    s_cmp_ge_u32 s3, 10
    s_cbranch_scc1 L_roleT
    s_branch L_roleW
L_earlyQ:
    s_mov_b32 s48, s16
    s_and_b32 s49, s17, 0xffff
    s_mov_b32 s50, 4096
    s_mov_b32 s51, 0x20000
    buffer_load_dwordx4 v[8:11], v4, s[48:51], 0 offen offset:0
    buffer_load_dwordx4 v[12:15], v4, s[48:51], 0 offen offset:1024
    buffer_load_dwordx4 v[16:19], v4, s[48:51], 0 offen offset:2048
    buffer_load_dwordx4 v[20:23], v4, s[48:51], 0 offen offset:3072
    s_branch L_roleQ
L_earlyT:
    s_mov_b32 s48, s28
    s_and_b32 s49, s29, 0xffff
    s_mov_b32 s50, 3584
    s_mov_b32 s51, 0x20000
    s_mov_b32 m0, 137216
    s_nop 0
    buffer_load_dwordx4 v4, s[48:51], 0 offen offset:0 lds
    buffer_load_dwordx4 v4, s[48:51], 0 offen offset:1024 lds
    buffer_load_dwordx4 v4, s[48:51], 0 offen offset:2048 lds
    buffer_load_dwordx4 v4, s[48:51], 0 offen offset:3072 lds
    s_mov_b32 s52, s30
    s_and_b32 s53, s31, 0xffff
    s_mov_b32 s54, 3584
    s_mov_b32 s55, 0x20000
    s_mov_b32 m0, 141312
    s_nop 0
    buffer_load_dwordx4 v4, s[52:55], 0 offen offset:0 lds
    buffer_load_dwordx4 v4, s[52:55], 0 offen offset:1024 lds
    buffer_load_dwordx4 v4, s[52:55], 0 offen offset:2048 lds
    buffer_load_dwordx4 v4, s[52:55], 0 offen offset:3072 lds
    s_mov_b32 s56, s32
    s_and_b32 s57, s33, 0xffff
    s_mov_b32 s58, 3584
    s_mov_b32 s59, 0x20000
    s_mov_b32 m0, 145408
    s_nop 0
    buffer_load_dwordx4 v4, s[56:59], 0 offen offset:0 lds
    buffer_load_dwordx4 v4, s[56:59], 0 offen offset:1024 lds
    buffer_load_dwordx4 v4, s[56:59], 0 offen offset:2048 lds
    buffer_load_dwordx4 v4, s[56:59], 0 offen offset:3072 lds
    s_waitcnt vmcnt(0)
    v_mov_b32 v3, 1
    s_mov_b64 exec, 1
    ds_write_b32 v2, v3 offset:5172
    s_mov_b64 exec, -1
    s_branch L_roleT
L_roleL:
    s_setprio 1
    v_lshrrev_b32 v4, 2, v0
    v_and_b32 v5, 3, v0
    v_lshlrev_b32 v5, 4, v5
    s_mov_b32 s43, 0
    s_mov_b32 s14, 0
    s_cmp_ge_u32 s5, 16
    s_cbranch_scc1 L_L_setup2
    s_mov_b32 s64, s22
    s_and_b32 s65, s23, 0xffff
    s_mov_b32 s66, 4194304
    s_mov_b32 s67, 0x20000
    v_lshrrev_b32 v6, 3, v0
    v_and_b32 v7, 7, v0
    v_lshlrev_b32 v7, 4, v7
    v_lshl_add_u32 v32, v6, 13, v7
    s_lshl_b32 s94, s4, 10
    s_and_b32 s10, s5, 7
    s_lshl_b32 s10, s10, 7
    s_add_u32 s94, s94, s10
    s_lshr_b32 s10, s5, 3
    s_lshl_b32 s10, s10, 21
    s_add_u32 s94, s94, s10
    s_mov_b32 s95, 98304
    v_add_u32 v33, 64512, v32
    v_add_u32 v34, 129024, v32
    v_add_u32 v35, 193536, v32
L_L_wq:
    s_mov_b32 m0, s95
    s_add_u32 s43, s43, 4
    buffer_load_dwordx4 v32, s[64:67], s94 offen offset:0 nt lds
    buffer_load_dwordx4 v33, s[64:67], s94 offen offset:1024 nt lds
    buffer_load_dwordx4 v34, s[64:67], s94 offen offset:2048 nt lds
    buffer_load_dwordx4 v35, s[64:67], s94 offen offset:3072 nt lds
    s_add_u32 s94, s94, 262144
    s_add_u32 s95, s95, 4096
    s_cmp_lt_u32 s43, 32
    s_cbranch_scc1 L_L_wq
L_L_setup2:
    s_mov_b32 s48, s18
    s_and_b32 s49, s19, 0xffff
    s_mov_b32 s50, 67108864
    s_mov_b32 s51, 0x20000
    v_lshrrev_b32 v8, 4, v0
    v_and_b32 v9, 15, v0
    v_add_u32 v6, 0, v8
    v_xor_b32 v7, v6, v9
    v_lshlrev_b32 v7, 4, v7
    v_lshl_add_u32 v20, v8, 8, v7
    v_add_u32 v6, 4, v8
    v_xor_b32 v7, v6, v9
    v_lshlrev_b32 v7, 4, v7
    v_lshl_add_u32 v21, v8, 8, v7
    v_add_u32 v6, 8, v8
    v_xor_b32 v7, v6, v9
    v_lshlrev_b32 v7, 4, v7
    v_lshl_add_u32 v22, v8, 8, v7
    v_add_u32 v6, 12, v8
    v_xor_b32 v7, v6, v9
    v_lshlrev_b32 v7, 4, v7
    v_lshl_add_u32 v23, v8, 8, v7
    s_lshl_b32 s9, s8, 21
    s_add_u32 s9, s9, 1572864
    s_lshl_b32 s10, s7, 16
    s_add_u32 s96, s9, s10
    s_cmp_lt_u32 s5, 16
    s_cbranch_scc1 L_L_setup3
    s_mov_b32 s94, s96
    s_mov_b32 s95, 0
L_L_k0:
    s_mov_b32 m0, s95
    s_add_u32 s43, s43, 4
    buffer_load_dwordx4 v20, s[48:51], s94 offen offset:0 nt lds
    buffer_load_dwordx4 v21, s[48:51], s94 offen offset:1024 nt lds
    buffer_load_dwordx4 v22, s[48:51], s94 offen offset:2048 nt lds
    buffer_load_dwordx4 v23, s[48:51], s94 offen offset:3072 nt lds
    s_add_u32 s94, s94, 4096
    s_add_u32 s95, s95, 4096
    s_cmp_lt_u32 s43, 8
    s_cbranch_scc1 L_L_k0
L_L_setup3:
    s_mov_b32 s52, s20
    s_and_b32 s53, s21, 0xffff
    s_mov_b32 s54, 67108864
    s_mov_b32 s55, 0x20000
    s_mov_b32 s56, s24
    s_and_b32 s57, s25, 0xffff
    s_mov_b32 s58, 4194304
    s_mov_b32 s59, 0x20000
    v_lshl_add_u32 v24, v4, 8, v5
    v_lshl_add_u32 v28, v4, 10, v5
    v_add_u32 v25, 3072, v24
    v_add_u32 v29, 15360, v28
    v_add_u32 v26, 6144, v24
    v_add_u32 v30, 30720, v28
    v_add_u32 v27, 9216, v24
    v_add_u32 v31, 46080, v28
    s_lshr_b32 s10, s7, 2
    s_lshl_b32 s10, s10, 18
    s_add_u32 s97, s9, s10
    s_and_b32 s10, s7, 3
    s_lshl_b32 s10, s10, 6
    s_add_u32 s97, s97, s10
    s_lshl_b32 s98, s4, 19
    s_sub_u32 s10, s5, 16
    s_lshl_b32 s10, s10, 6
    s_add_u32 s98, s98, s10
    s_cmp_ge_u32 s5, 16
    s_cbranch_scc1 L_L_wo
    s_mov_b32 s94, s96
    s_mov_b32 s95, 0
    s_mov_b32 s11, 16
Ls_1:
    s_mov_b32 m0, s95
    s_sub_i32 s10, s43, 24
    s_max_i32 s14, s10, s14
    v_mov_b32 v3, s14
    s_mov_b64 exec, 1
    s_waitcnt vmcnt(24)
    ds_write_b32 v2, v3 offset:5128
    s_mov_b64 exec, -1
    buffer_load_dwordx4 v20, s[48:51], s94 offen offset:0 nt lds
    buffer_load_dwordx4 v21, s[48:51], s94 offen offset:1024 nt lds
    buffer_load_dwordx4 v22, s[48:51], s94 offen offset:2048 nt lds
    buffer_load_dwordx4 v23, s[48:51], s94 offen offset:3072 nt lds
    s_add_u32 s94, s94, 4096
    s_add_u32 s95, s95, 4096
    s_add_u32 s43, s43, 4
    s_sub_u32 s11, s11, 1
    s_cmp_lg_u32 s11, 0
    s_cbranch_scc1 Ls_1
    s_mov_b32 s94, s97
    s_mov_b32 s95, 65536
    s_mov_b32 s11, 8
Ls_2:
    s_mov_b32 m0, s95
    s_sub_i32 s10, s43, 24
    s_max_i32 s14, s10, s14
    v_mov_b32 v3, s14
    s_mov_b64 exec, 1
    s_waitcnt vmcnt(24)
    ds_write_b32 v2, v3 offset:5128
    s_mov_b64 exec, -1
    buffer_load_dwordx4 v24, s[52:55], s94 offen offset:0 nt lds
    buffer_load_dwordx4 v25, s[52:55], s94 offen offset:1024 nt lds
    buffer_load_dwordx4 v26, s[52:55], s94 offen offset:2048 nt lds
    buffer_load_dwordx4 v27, s[52:55], s94 offen offset:3072 nt lds
    s_add_u32 s94, s94, 16384
    s_add_u32 s95, s95, 4096
    s_add_u32 s43, s43, 4
    s_sub_u32 s11, s11, 1
    s_cmp_lg_u32 s11, 0
    s_cbranch_scc1 Ls_2
    s_mov_b32 s13, 0x40000
Lw_3:
    ds_read_b32 v3, v2 offset:5120
    s_waitcnt lgkmcnt(0)
    v_readfirstlane_b32 s12, v3
    s_nop 0
    s_cmp_ge_u32 s12, 1
    s_cbranch_scc1 Lwd_4
    s_sub_u32 s13, s13, 1
    s_cbranch_scc1 Lwd_4
    s_sleep 1
    s_branch Lw_3
Lwd_4:
    s_mov_b32 s11, 8
Ls_5:
    s_mov_b32 m0, s95
    s_sub_i32 s10, s43, 24
    s_max_i32 s14, s10, s14
    v_mov_b32 v3, s14
    s_mov_b64 exec, 1
    s_waitcnt vmcnt(24)
    ds_write_b32 v2, v3 offset:5128
    s_mov_b64 exec, -1
    buffer_load_dwordx4 v24, s[52:55], s94 offen offset:0 nt lds
    buffer_load_dwordx4 v25, s[52:55], s94 offen offset:1024 nt lds
    buffer_load_dwordx4 v26, s[52:55], s94 offen offset:2048 nt lds
    buffer_load_dwordx4 v27, s[52:55], s94 offen offset:3072 nt lds
    s_add_u32 s94, s94, 16384
    s_add_u32 s95, s95, 4096
    s_add_u32 s43, s43, 4
    s_sub_u32 s11, s11, 1
    s_cmp_lg_u32 s11, 0
    s_cbranch_scc1 Ls_5
    s_waitcnt vmcnt(24)
    v_mov_b32 v3, 136
    s_mov_b64 exec, 1
    ds_write_b32 v2, v3 offset:5128
    s_mov_b64 exec, -1
    s_waitcnt vmcnt(20)
    v_mov_b32 v3, 140
    s_mov_b64 exec, 1
    ds_write_b32 v2, v3 offset:5128
    s_mov_b64 exec, -1
    s_waitcnt vmcnt(16)
    v_mov_b32 v3, 144
    s_mov_b64 exec, 1
    ds_write_b32 v2, v3 offset:5128
    s_mov_b64 exec, -1
    s_waitcnt vmcnt(12)
    v_mov_b32 v3, 148
    s_mov_b64 exec, 1
    ds_write_b32 v2, v3 offset:5128
    s_mov_b64 exec, -1
    s_waitcnt vmcnt(8)
    v_mov_b32 v3, 152
    s_mov_b64 exec, 1
    ds_write_b32 v2, v3 offset:5128
    s_mov_b64 exec, -1
    s_waitcnt vmcnt(4)
    v_mov_b32 v3, 156
    s_mov_b64 exec, 1
    ds_write_b32 v2, v3 offset:5128
    s_mov_b64 exec, -1
    s_waitcnt vmcnt(0)
    v_mov_b32 v3, 160
    s_mov_b64 exec, 1
    ds_write_b32 v2, v3 offset:5128
    s_mov_b64 exec, -1
    s_branch L_L_done
L_L_wo:
    s_mov_b32 s11, 2
Ls_6:
    s_mov_b32 m0, s95
    s_sub_i32 s10, s43, 4
    s_max_i32 s14, s10, s14
    v_mov_b32 v3, s14
    s_mov_b64 exec, 1
    s_waitcnt vmcnt(4)
    ds_write_b32 v2, v3 offset:5128
    s_mov_b64 exec, -1
    buffer_load_dwordx4 v20, s[48:51], s94 offen offset:0 nt lds
    buffer_load_dwordx4 v21, s[48:51], s94 offen offset:1024 nt lds
    buffer_load_dwordx4 v22, s[48:51], s94 offen offset:2048 nt lds
    buffer_load_dwordx4 v23, s[48:51], s94 offen offset:3072 nt lds
    s_add_u32 s94, s94, 4096
    s_add_u32 s95, s95, 4096
    s_add_u32 s43, s43, 4
    s_sub_u32 s11, s11, 1
    s_cmp_lg_u32 s11, 0
    s_cbranch_scc1 Ls_6
    s_mov_b32 s11, 12
Ls_7:
    s_mov_b32 m0, s95
    s_sub_i32 s10, s43, 16
    s_max_i32 s14, s10, s14
    v_mov_b32 v3, s14
    s_mov_b64 exec, 1
    s_waitcnt vmcnt(16)
    ds_write_b32 v2, v3 offset:5128
    s_mov_b64 exec, -1
    buffer_load_dwordx4 v20, s[48:51], s94 offen offset:0 nt lds
    buffer_load_dwordx4 v21, s[48:51], s94 offen offset:1024 nt lds
    buffer_load_dwordx4 v22, s[48:51], s94 offen offset:2048 nt lds
    buffer_load_dwordx4 v23, s[48:51], s94 offen offset:3072 nt lds
    s_add_u32 s94, s94, 4096
    s_add_u32 s95, s95, 4096
    s_add_u32 s43, s43, 4
    s_sub_u32 s11, s11, 1
    s_cmp_lg_u32 s11, 0
    s_cbranch_scc1 Ls_7
    s_mov_b32 s94, s97
    s_mov_b32 s95, 65536
    s_mov_b32 s11, 16
Ls_8:
    s_mov_b32 m0, s95
    s_sub_i32 s10, s43, 20
    s_max_i32 s14, s10, s14
    v_mov_b32 v3, s14
    s_mov_b64 exec, 1
    s_waitcnt vmcnt(20)
    ds_write_b32 v2, v3 offset:5128
    s_mov_b64 exec, -1
    buffer_load_dwordx4 v24, s[52:55], s94 offen offset:0 nt lds
    buffer_load_dwordx4 v25, s[52:55], s94 offen offset:1024 nt lds
    buffer_load_dwordx4 v26, s[52:55], s94 offen offset:2048 nt lds
    buffer_load_dwordx4 v27, s[52:55], s94 offen offset:3072 nt lds
    s_add_u32 s94, s94, 16384
    s_add_u32 s95, s95, 4096
    s_add_u32 s43, s43, 4
    s_sub_u32 s11, s11, 1
    s_cmp_lg_u32 s11, 0
    s_cbranch_scc1 Ls_8
    s_mov_b32 s13, 0x40000
Lw_9:
    ds_read_b32 v3, v2 offset:5144
    s_waitcnt lgkmcnt(0)
    v_readfirstlane_b32 s12, v3
    s_nop 0
    s_cmp_ge_u32 s12, 8
    s_cbranch_scc1 Lwd_10
    s_sub_u32 s13, s13, 1
    s_cbranch_scc1 Lwd_10
    s_sleep 1
    s_branch Lw_9
Lwd_10:
    s_mov_b32 s94, s98
    s_mov_b32 s95, 0
    s_mov_b32 s11, 8
Ls_11:
    s_mov_b32 m0, s95
    s_sub_i32 s10, s43, 20
    s_max_i32 s14, s10, s14
    v_mov_b32 v3, s14
    s_mov_b64 exec, 1
    s_waitcnt vmcnt(20)
    ds_write_b32 v2, v3 offset:5128
    s_mov_b64 exec, -1
    buffer_load_dwordx4 v28, s[56:59], s94 offen offset:0 nt lds
    buffer_load_dwordx4 v29, s[56:59], s94 offen offset:1024 nt lds
    buffer_load_dwordx4 v30, s[56:59], s94 offen offset:2048 nt lds
    buffer_load_dwordx4 v31, s[56:59], s94 offen offset:3072 nt lds
    s_add_u32 s94, s94, 65536
    s_add_u32 s95, s95, 4096
    s_add_u32 s43, s43, 4
    s_sub_u32 s11, s11, 1
    s_cmp_lg_u32 s11, 0
    s_cbranch_scc1 Ls_11
    s_waitcnt vmcnt(20)
    v_mov_b32 v3, 140
    s_mov_b64 exec, 1
    ds_write_b32 v2, v3 offset:5128
    s_mov_b64 exec, -1
    s_waitcnt vmcnt(16)
    v_mov_b32 v3, 144
    s_mov_b64 exec, 1
    ds_write_b32 v2, v3 offset:5128
    s_mov_b64 exec, -1
    s_waitcnt vmcnt(12)
    v_mov_b32 v3, 148
    s_mov_b64 exec, 1
    ds_write_b32 v2, v3 offset:5128
    s_mov_b64 exec, -1
    s_waitcnt vmcnt(8)
    v_mov_b32 v3, 152
    s_mov_b64 exec, 1
    ds_write_b32 v2, v3 offset:5128
    s_mov_b64 exec, -1
    s_waitcnt vmcnt(4)
    v_mov_b32 v3, 156
    s_mov_b64 exec, 1
    ds_write_b32 v2, v3 offset:5128
    s_mov_b64 exec, -1
    s_waitcnt vmcnt(0)
    v_mov_b32 v3, 160
    s_mov_b64 exec, 1
    ds_write_b32 v2, v3 offset:5128
    s_mov_b64 exec, -1
L_L_done:
    s_endpgm
L_roleQ:
    s_setprio 3
    s_mov_b32 s56, s36
    s_and_b32 s57, s37, 0xffff
    s_mov_b32 s58, 4096
    s_mov_b32 s59, 0x20000
    s_lshl_b32 s10, s6, 10
    buffer_load_dwordx4 v[120:123], v4, s[56:59], s10 offen
    s_getpc_b64 s[10:11]
L_pc_here:
    s_sub_u32 s10, s10, L_pc_here - sequential_preLN__sliding_block_cached__mixer_token_mlp__decode_kernel
    s_subb_u32 s11, s11, 0
    s_lshl_b32 s12, s5, 10
    v_add_u32 v7, s12, v4
    v_min_u32 v7, L_code_end - sequential_preLN__sliding_block_cached__mixer_token_mlp__decode_kernel - 16, v7
    global_load_dwordx4 v[124:127], v7, s[10:11]
    s_cmp_ge_u32 s5, 16
    s_cbranch_scc1 L_Q_gather
    s_waitcnt vmcnt(2)
    v_lshlrev_b32 v24, 16, v8
    v_and_b32 v25, 0xffff0000, v8
    v_lshlrev_b32 v26, 16, v9
    v_and_b32 v27, 0xffff0000, v9
    v_lshlrev_b32 v28, 16, v10
    v_and_b32 v29, 0xffff0000, v10
    v_lshlrev_b32 v30, 16, v11
    v_and_b32 v31, 0xffff0000, v11
    v_lshlrev_b32 v32, 16, v12
    v_and_b32 v33, 0xffff0000, v12
    v_lshlrev_b32 v34, 16, v13
    v_and_b32 v35, 0xffff0000, v13
    v_lshlrev_b32 v36, 16, v14
    v_and_b32 v37, 0xffff0000, v14
    v_lshlrev_b32 v38, 16, v15
    v_and_b32 v39, 0xffff0000, v15
    v_lshlrev_b32 v40, 16, v16
    v_and_b32 v41, 0xffff0000, v16
    v_lshlrev_b32 v42, 16, v17
    v_and_b32 v43, 0xffff0000, v17
    v_lshlrev_b32 v44, 16, v18
    v_and_b32 v45, 0xffff0000, v18
    v_lshlrev_b32 v46, 16, v19
    v_and_b32 v47, 0xffff0000, v19
    v_lshlrev_b32 v48, 16, v20
    v_and_b32 v49, 0xffff0000, v20
    v_lshlrev_b32 v50, 16, v21
    v_and_b32 v51, 0xffff0000, v21
    v_lshlrev_b32 v52, 16, v22
    v_and_b32 v53, 0xffff0000, v22
    v_lshlrev_b32 v54, 16, v23
    v_and_b32 v55, 0xffff0000, v23
    v_add_f32 v56, v24, v25
    v_add_f32 v60, v26, v27
    v_add_f32 v57, v32, v33
    v_add_f32 v61, v34, v35
    v_add_f32 v58, v40, v41
    v_add_f32 v62, v42, v43
    v_add_f32 v59, v48, v49
    v_add_f32 v63, v50, v51
    v_add_f32 v56, v56, v28
    v_add_f32 v60, v60, v29
    v_add_f32 v57, v57, v36
    v_add_f32 v61, v61, v37
    v_add_f32 v58, v58, v44
    v_add_f32 v62, v62, v45
    v_add_f32 v59, v59, v52
    v_add_f32 v63, v63, v53
    v_add_f32 v56, v56, v30
    v_add_f32 v60, v60, v31
    v_add_f32 v57, v57, v38
    v_add_f32 v61, v61, v39
    v_add_f32 v58, v58, v46
    v_add_f32 v62, v62, v47
    v_add_f32 v59, v59, v54
    v_add_f32 v63, v63, v55
    v_add_f32 v56, v56, v60
    v_add_f32 v57, v57, v61
    v_add_f32 v58, v58, v62
    v_add_f32 v59, v59, v63
    v_add_f32_dpp v56, v56, v56 quad_perm:[1,0,3,2] row_mask:0xf bank_mask:0xf
    v_add_f32_dpp v57, v57, v57 quad_perm:[1,0,3,2] row_mask:0xf bank_mask:0xf
    v_add_f32_dpp v58, v58, v58 quad_perm:[1,0,3,2] row_mask:0xf bank_mask:0xf
    v_add_f32_dpp v59, v59, v59 quad_perm:[1,0,3,2] row_mask:0xf bank_mask:0xf
    v_add_f32_dpp v56, v56, v56 quad_perm:[2,3,0,1] row_mask:0xf bank_mask:0xf
    v_add_f32_dpp v57, v57, v57 quad_perm:[2,3,0,1] row_mask:0xf bank_mask:0xf
    v_add_f32_dpp v58, v58, v58 quad_perm:[2,3,0,1] row_mask:0xf bank_mask:0xf
    v_add_f32_dpp v59, v59, v59 quad_perm:[2,3,0,1] row_mask:0xf bank_mask:0xf
    v_add_f32_dpp v56, v56, v56 row_half_mirror row_mask:0xf bank_mask:0xf
    v_add_f32_dpp v57, v57, v57 row_half_mirror row_mask:0xf bank_mask:0xf
    v_add_f32_dpp v58, v58, v58 row_half_mirror row_mask:0xf bank_mask:0xf
    v_add_f32_dpp v59, v59, v59 row_half_mirror row_mask:0xf bank_mask:0xf
    v_add_f32_dpp v56, v56, v56 row_mirror row_mask:0xf bank_mask:0xf
    v_add_f32_dpp v57, v57, v57 row_mirror row_mask:0xf bank_mask:0xf
    v_add_f32_dpp v58, v58, v58 row_mirror row_mask:0xf bank_mask:0xf
    v_add_f32_dpp v59, v59, v59 row_mirror row_mask:0xf bank_mask:0xf
    v_mov_b32 v60, v56
    v_mov_b32 v61, v57
    v_mov_b32 v62, v58
    v_mov_b32 v63, v59
    v_permlane16_swap_b32 v56, v60
    v_permlane16_swap_b32 v57, v61
    v_permlane16_swap_b32 v58, v62
    v_permlane16_swap_b32 v59, v63
    v_add_f32 v56, v56, v60
    v_add_f32 v57, v57, v61
    v_add_f32 v58, v58, v62
    v_add_f32 v59, v59, v63
    v_mov_b32 v60, v56
    v_mov_b32 v61, v57
    v_mov_b32 v62, v58
    v_mov_b32 v63, v59
    v_permlane32_swap_b32 v56, v60
    v_permlane32_swap_b32 v57, v61
    v_permlane32_swap_b32 v58, v62
    v_permlane32_swap_b32 v59, v63
    v_add_f32 v56, v56, v60
    v_add_f32 v57, v57, v61
    v_add_f32 v58, v58, v62
    v_add_f32 v59, v59, v63
    v_mul_f32 v56, 0x3b000000, v56
    v_mul_f32 v57, 0x3b000000, v57
    v_mul_f32 v58, 0x3b000000, v58
    v_mul_f32 v59, 0x3b000000, v59
    v_sub_f32 v68, v24, v56
    v_sub_f32 v69, v25, v56
    v_sub_f32 v70, v26, v56
    v_sub_f32 v71, v27, v56
    v_sub_f32 v72, v28, v56
    v_sub_f32 v73, v29, v56
    v_sub_f32 v74, v30, v56
    v_sub_f32 v75, v31, v56
    v_sub_f32 v76, v32, v57
    v_sub_f32 v77, v33, v57
    v_sub_f32 v78, v34, v57
    v_sub_f32 v79, v35, v57
    v_sub_f32 v80, v36, v57
    v_sub_f32 v81, v37, v57
    v_sub_f32 v82, v38, v57
    v_sub_f32 v83, v39, v57
    v_sub_f32 v84, v40, v58
    v_sub_f32 v85, v41, v58
    v_sub_f32 v86, v42, v58
    v_sub_f32 v87, v43, v58
    v_sub_f32 v88, v44, v58
    v_sub_f32 v89, v45, v58
    v_sub_f32 v90, v46, v58
    v_sub_f32 v91, v47, v58
    v_sub_f32 v92, v48, v59
    v_sub_f32 v93, v49, v59
    v_sub_f32 v94, v50, v59
    v_sub_f32 v95, v51, v59
    v_sub_f32 v96, v52, v59
    v_sub_f32 v97, v53, v59
    v_sub_f32 v98, v54, v59
    v_sub_f32 v99, v55, v59
    v_cvt_pk_bf16_f32 v64, v56, v56
    v_lshlrev_b32 v64, 16, v64
    v_cvt_pk_bf16_f32 v65, v57, v57
    v_lshlrev_b32 v65, 16, v65
    v_cvt_pk_bf16_f32 v66, v58, v58
    v_lshlrev_b32 v66, 16, v66
    v_cvt_pk_bf16_f32 v67, v59, v59
    v_lshlrev_b32 v67, 16, v67
    v_mul_f32 v56, v68, v68
    v_mul_f32 v60, v69, v69
    v_mul_f32 v57, v76, v76
    v_mul_f32 v61, v77, v77
    v_mul_f32 v58, v84, v84
    v_mul_f32 v62, v85, v85
    v_mul_f32 v59, v92, v92
    v_mul_f32 v63, v93, v93
    v_fmac_f32 v56, v70, v70
    v_fmac_f32 v60, v71, v71
    v_fmac_f32 v57, v78, v78
    v_fmac_f32 v61, v79, v79
    v_fmac_f32 v58, v86, v86
    v_fmac_f32 v62, v87, v87
    v_fmac_f32 v59, v94, v94
    v_fmac_f32 v63, v95, v95
    v_fmac_f32 v56, v72, v72
    v_fmac_f32 v60, v73, v73
    v_fmac_f32 v57, v80, v80
    v_fmac_f32 v61, v81, v81
    v_fmac_f32 v58, v88, v88
    v_fmac_f32 v62, v89, v89
    v_fmac_f32 v59, v96, v96
    v_fmac_f32 v63, v97, v97
    v_fmac_f32 v56, v74, v74
    v_fmac_f32 v60, v75, v75
    v_fmac_f32 v57, v82, v82
    v_fmac_f32 v61, v83, v83
    v_fmac_f32 v58, v90, v90
    v_fmac_f32 v62, v91, v91
    v_fmac_f32 v59, v98, v98
    v_fmac_f32 v63, v99, v99
    v_add_f32 v56, v56, v60
    v_add_f32 v57, v57, v61
    v_add_f32 v58, v58, v62
    v_add_f32 v59, v59, v63
    v_add_f32_dpp v56, v56, v56 quad_perm:[1,0,3,2] row_mask:0xf bank_mask:0xf
    v_add_f32_dpp v57, v57, v57 quad_perm:[1,0,3,2] row_mask:0xf bank_mask:0xf
    v_add_f32_dpp v58, v58, v58 quad_perm:[1,0,3,2] row_mask:0xf bank_mask:0xf
    v_add_f32_dpp v59, v59, v59 quad_perm:[1,0,3,2] row_mask:0xf bank_mask:0xf
    v_add_f32_dpp v56, v56, v56 quad_perm:[2,3,0,1] row_mask:0xf bank_mask:0xf
    v_add_f32_dpp v57, v57, v57 quad_perm:[2,3,0,1] row_mask:0xf bank_mask:0xf
    v_add_f32_dpp v58, v58, v58 quad_perm:[2,3,0,1] row_mask:0xf bank_mask:0xf
    v_add_f32_dpp v59, v59, v59 quad_perm:[2,3,0,1] row_mask:0xf bank_mask:0xf
    v_add_f32_dpp v56, v56, v56 row_half_mirror row_mask:0xf bank_mask:0xf
    v_add_f32_dpp v57, v57, v57 row_half_mirror row_mask:0xf bank_mask:0xf
    v_add_f32_dpp v58, v58, v58 row_half_mirror row_mask:0xf bank_mask:0xf
    v_add_f32_dpp v59, v59, v59 row_half_mirror row_mask:0xf bank_mask:0xf
    v_add_f32_dpp v56, v56, v56 row_mirror row_mask:0xf bank_mask:0xf
    v_add_f32_dpp v57, v57, v57 row_mirror row_mask:0xf bank_mask:0xf
    v_add_f32_dpp v58, v58, v58 row_mirror row_mask:0xf bank_mask:0xf
    v_add_f32_dpp v59, v59, v59 row_mirror row_mask:0xf bank_mask:0xf
    v_mov_b32 v60, v56
    v_mov_b32 v61, v57
    v_mov_b32 v62, v58
    v_mov_b32 v63, v59
    v_permlane16_swap_b32 v56, v60
    v_permlane16_swap_b32 v57, v61
    v_permlane16_swap_b32 v58, v62
    v_permlane16_swap_b32 v59, v63
    v_add_f32 v56, v56, v60
    v_add_f32 v57, v57, v61
    v_add_f32 v58, v58, v62
    v_add_f32 v59, v59, v63
    v_mov_b32 v60, v56
    v_mov_b32 v61, v57
    v_mov_b32 v62, v58
    v_mov_b32 v63, v59
    v_permlane32_swap_b32 v56, v60
    v_permlane32_swap_b32 v57, v61
    v_permlane32_swap_b32 v58, v62
    v_permlane32_swap_b32 v59, v63
    v_add_f32 v56, v56, v60
    v_add_f32 v57, v57, v61
    v_add_f32 v58, v58, v62
    v_add_f32 v59, v59, v63
    v_mul_f32 v56, 0x3b000000, v56
    v_mul_f32 v57, 0x3b000000, v57
    v_mul_f32 v58, 0x3b000000, v58
    v_mul_f32 v59, 0x3b000000, v59
    v_cvt_pk_bf16_f32 v56, v56, v56
    v_lshlrev_b32 v56, 16, v56
    v_cvt_pk_bf16_f32 v57, v57, v57
    v_lshlrev_b32 v57, 16, v57
    v_cvt_pk_bf16_f32 v58, v58, v58
    v_lshlrev_b32 v58, 16, v58
    v_cvt_pk_bf16_f32 v59, v59, v59
    v_lshlrev_b32 v59, 16, v59
    v_add_f32 v56, 0x3727c5ac, v56
    v_add_f32 v57, 0x3727c5ac, v57
    v_add_f32 v58, 0x3727c5ac, v58
    v_add_f32 v59, 0x3727c5ac, v59
    v_cvt_pk_bf16_f32 v56, v56, v56
    v_lshlrev_b32 v56, 16, v56
    v_cvt_pk_bf16_f32 v57, v57, v57
    v_lshlrev_b32 v57, 16, v57
    v_cvt_pk_bf16_f32 v58, v58, v58
    v_lshlrev_b32 v58, 16, v58
    v_cvt_pk_bf16_f32 v59, v59, v59
    v_lshlrev_b32 v59, 16, v59
    v_sqrt_f32 v56, v56
    v_sqrt_f32 v57, v57
    v_sqrt_f32 v58, v58
    v_sqrt_f32 v59, v59
    v_cvt_pk_bf16_f32 v56, v56, v56
    v_lshlrev_b32 v56, 16, v56
    v_cvt_pk_bf16_f32 v57, v57, v57
    v_lshlrev_b32 v57, 16, v57
    v_cvt_pk_bf16_f32 v58, v58, v58
    v_lshlrev_b32 v58, 16, v58
    v_cvt_pk_bf16_f32 v59, v59, v59
    v_lshlrev_b32 v59, 16, v59
    v_rcp_f32 v56, v56
    v_rcp_f32 v57, v57
    v_rcp_f32 v58, v58
    v_rcp_f32 v59, v59
    v_sub_f32 v68, v24, v64
    v_sub_f32 v69, v25, v64
    v_sub_f32 v70, v26, v64
    v_sub_f32 v71, v27, v64
    v_sub_f32 v72, v28, v64
    v_sub_f32 v73, v29, v64
    v_sub_f32 v74, v30, v64
    v_sub_f32 v75, v31, v64
    v_sub_f32 v76, v32, v65
    v_sub_f32 v77, v33, v65
    v_sub_f32 v78, v34, v65
    v_sub_f32 v79, v35, v65
    v_sub_f32 v80, v36, v65
    v_sub_f32 v81, v37, v65
    v_sub_f32 v82, v38, v65
    v_sub_f32 v83, v39, v65
    v_sub_f32 v84, v40, v66
    v_sub_f32 v85, v41, v66
    v_sub_f32 v86, v42, v66
    v_sub_f32 v87, v43, v66
    v_sub_f32 v88, v44, v66
    v_sub_f32 v89, v45, v66
    v_sub_f32 v90, v46, v66
    v_sub_f32 v91, v47, v66
    v_sub_f32 v92, v48, v67
    v_sub_f32 v93, v49, v67
    v_sub_f32 v94, v50, v67
    v_sub_f32 v95, v51, v67
    v_sub_f32 v96, v52, v67
    v_sub_f32 v97, v53, v67
    v_sub_f32 v98, v54, v67
    v_sub_f32 v99, v55, v67
    v_cvt_pk_bf16_f32 v24, v68, v69
    v_cvt_pk_bf16_f32 v26, v70, v71
    v_cvt_pk_bf16_f32 v28, v72, v73
    v_cvt_pk_bf16_f32 v30, v74, v75
    v_cvt_pk_bf16_f32 v32, v76, v77
    v_cvt_pk_bf16_f32 v34, v78, v79
    v_cvt_pk_bf16_f32 v36, v80, v81
    v_cvt_pk_bf16_f32 v38, v82, v83
    v_cvt_pk_bf16_f32 v40, v84, v85
    v_cvt_pk_bf16_f32 v42, v86, v87
    v_cvt_pk_bf16_f32 v44, v88, v89
    v_cvt_pk_bf16_f32 v46, v90, v91
    v_cvt_pk_bf16_f32 v48, v92, v93
    v_cvt_pk_bf16_f32 v50, v94, v95
    v_cvt_pk_bf16_f32 v52, v96, v97
    v_cvt_pk_bf16_f32 v54, v98, v99
    v_lshlrev_b32 v68, 16, v24
    v_and_b32 v69, 0xffff0000, v24
    v_lshlrev_b32 v70, 16, v26
    v_and_b32 v71, 0xffff0000, v26
    v_lshlrev_b32 v72, 16, v28
    v_and_b32 v73, 0xffff0000, v28
    v_lshlrev_b32 v74, 16, v30
    v_and_b32 v75, 0xffff0000, v30
    v_lshlrev_b32 v76, 16, v32
    v_and_b32 v77, 0xffff0000, v32
    v_lshlrev_b32 v78, 16, v34
    v_and_b32 v79, 0xffff0000, v34
    v_lshlrev_b32 v80, 16, v36
    v_and_b32 v81, 0xffff0000, v36
    v_lshlrev_b32 v82, 16, v38
    v_and_b32 v83, 0xffff0000, v38
    v_lshlrev_b32 v84, 16, v40
    v_and_b32 v85, 0xffff0000, v40
    v_lshlrev_b32 v86, 16, v42
    v_and_b32 v87, 0xffff0000, v42
    v_lshlrev_b32 v88, 16, v44
    v_and_b32 v89, 0xffff0000, v44
    v_lshlrev_b32 v90, 16, v46
    v_and_b32 v91, 0xffff0000, v46
    v_lshlrev_b32 v92, 16, v48
    v_and_b32 v93, 0xffff0000, v48
    v_lshlrev_b32 v94, 16, v50
    v_and_b32 v95, 0xffff0000, v50
    v_lshlrev_b32 v96, 16, v52
    v_and_b32 v97, 0xffff0000, v52
    v_lshlrev_b32 v98, 16, v54
    v_and_b32 v99, 0xffff0000, v54
    v_mul_f32 v68, v68, v56
    v_mul_f32 v69, v69, v56
    v_mul_f32 v70, v70, v56
    v_mul_f32 v71, v71, v56
    v_mul_f32 v72, v72, v56
    v_mul_f32 v73, v73, v56
    v_mul_f32 v74, v74, v56
    v_mul_f32 v75, v75, v56
    v_mul_f32 v76, v76, v57
    v_mul_f32 v77, v77, v57
    v_mul_f32 v78, v78, v57
    v_mul_f32 v79, v79, v57
    v_mul_f32 v80, v80, v57
    v_mul_f32 v81, v81, v57
    v_mul_f32 v82, v82, v57
    v_mul_f32 v83, v83, v57
    v_mul_f32 v84, v84, v58
    v_mul_f32 v85, v85, v58
    v_mul_f32 v86, v86, v58
    v_mul_f32 v87, v87, v58
    v_mul_f32 v88, v88, v58
    v_mul_f32 v89, v89, v58
    v_mul_f32 v90, v90, v58
    v_mul_f32 v91, v91, v58
    v_mul_f32 v92, v92, v59
    v_mul_f32 v93, v93, v59
    v_mul_f32 v94, v94, v59
    v_mul_f32 v95, v95, v59
    v_mul_f32 v96, v96, v59
    v_mul_f32 v97, v97, v59
    v_mul_f32 v98, v98, v59
    v_mul_f32 v99, v99, v59
    v_cvt_pk_bf16_f32 v8, v68, v69
    v_cvt_pk_bf16_f32 v9, v70, v71
    v_cvt_pk_bf16_f32 v10, v72, v73
    v_cvt_pk_bf16_f32 v11, v74, v75
    v_cvt_pk_bf16_f32 v12, v76, v77
    v_cvt_pk_bf16_f32 v13, v78, v79
    v_cvt_pk_bf16_f32 v14, v80, v81
    v_cvt_pk_bf16_f32 v15, v82, v83
    v_cvt_pk_bf16_f32 v16, v84, v85
    v_cvt_pk_bf16_f32 v17, v86, v87
    v_cvt_pk_bf16_f32 v18, v88, v89
    v_cvt_pk_bf16_f32 v19, v90, v91
    v_cvt_pk_bf16_f32 v20, v92, v93
    v_cvt_pk_bf16_f32 v21, v94, v95
    v_cvt_pk_bf16_f32 v22, v96, v97
    v_cvt_pk_bf16_f32 v23, v98, v99
    v_add_u32 v5, v4, v2
    ds_write_b128 v5, v[8:11] offset:0
    ds_write_b128 v5, v[12:15] offset:1024
    ds_write_b128 v5, v[16:19] offset:2048
    ds_write_b128 v5, v[20:23] offset:3072
    s_waitcnt lgkmcnt(0)
    s_add_u32 s60, s62, 0x7f4a7c15
    s_addc_u32 s61, s63, 0x9e3779b9
    s_getreg_b32 s95, hwreg(HW_REG_XCC_ID)
    s_and_b32 s95, s95, 0xf
    s_lshl_b32 s12, s4, 9
    s_lshl_b32 s13, s5, 4
    s_add_u32 s12, s12, s13
    s_add_u32 s12, s12, 32768
    v_mov_b32 v108, s95
    v_mov_b32 v109, 0
    v_mov_b32 v110, s60
    v_mov_b32 v111, s61
    s_mov_b64 exec, 1
    buffer_store_dwordx4 v[108:111], v109, s[44:47], s12 offen sc1
    s_mov_b64 exec, -1
    v_lshrrev_b32 v5, 2, v0
    v_and_b32 v6, 3, v0
    v_lshlrev_b32 v7, 3, v6
    v_lshl_add_u32 v5, v5, 7, v7
    v_add_u32 v5, 98304, v5
    v_lshrrev_b32 v7, 4, v0
    v_lshlrev_b32 v7, 3, v7
    v_lshl_add_u32 v6, v6, 10, v7
    s_lshr_b32 s10, s5, 3
    s_lshl_b32 s10, s10, 9
    v_add3_u32 v6, v6, v2, s10
    ds_read2_b64 v[8:11], v6 offset0:0 offset1:4
    ds_read2_b64 v[12:15], v6 offset0:8 offset1:12
    ds_read2_b64 v[16:19], v6 offset0:16 offset1:20
    ds_read2_b64 v[20:23], v6 offset0:24 offset1:28
    ds_read2_b64 v[24:27], v6 offset0:32 offset1:36
    ds_read2_b64 v[28:31], v6 offset0:40 offset1:44
    ds_read2_b64 v[32:35], v6 offset0:48 offset1:52
    ds_read2_b64 v[36:39], v6 offset0:56 offset1:60
    v_and_b32 v6, 3, v0
    v_lshlrev_b32 v6, 16, v6
    v_lshrrev_b32 v7, 4, v0
    v_lshl_add_u32 v6, v7, 4, v6
    v_bfe_u32 v7, v0, 2, 2
    v_lshl_add_u32 v6, v7, 6, v6
    v_cmp_eq_u32 s[64:65], 1, v7
    v_cmp_eq_u32 s[66:67], 2, v7
    v_cmp_eq_u32 s[68:69], 3, v7
    s_lshl_b32 s10, s4, 13
    s_and_b32 s11, s5, 7
    s_lshl_b32 s11, s11, 8
    s_add_u32 s10, s10, s11
    s_lshr_b32 s11, s5, 3
    s_lshl_b32 s11, s11, 12
    s_add_u32 s10, s10, s11
    s_add_u32 s10, s10, 720896
    s_add_u32 s11, s10, 2097152
    v_mov_b32 v82, s60
    v_mov_b32 v83, s61
    v_mov_b32 v86, s60
    v_mov_b32 v87, s61
    s_mov_b32 s13, 0x40000
Lw_12:
    ds_read_b32 v3, v2 offset:5128
    s_waitcnt lgkmcnt(0)
    v_readfirstlane_b32 s12, v3
    s_nop 0
    s_cmp_ge_u32 s12, 8
    s_cbranch_scc1 Lwd_13
    s_sub_u32 s13, s13, 1
    s_cbranch_scc1 Lwd_13
    s_sleep 1
    s_branch Lw_12
Lwd_13:
    ds_read_b64_tr_b16 v[88:89], v5 offset:0
    ds_read_b64_tr_b16 v[90:91], v5 offset:2048
    ds_read_b64_tr_b16 v[92:93], v5 offset:32
    ds_read_b64_tr_b16 v[94:95], v5 offset:2080
    ds_read_b64_tr_b16 v[96:97], v5 offset:64
    ds_read_b64_tr_b16 v[98:99], v5 offset:2112
    ds_read_b64_tr_b16 v[100:101], v5 offset:96
    ds_read_b64_tr_b16 v[102:103], v5 offset:2144
    s_waitcnt lgkmcnt(4)
    ds_read_b64_tr_b16 v[104:105], v5 offset:4096
    ds_read_b64_tr_b16 v[106:107], v5 offset:6144
    ds_read_b64_tr_b16 v[108:109], v5 offset:4128
    ds_read_b64_tr_b16 v[110:111], v5 offset:6176
    ds_read_b64_tr_b16 v[112:113], v5 offset:4160
    ds_read_b64_tr_b16 v[114:115], v5 offset:6208
    ds_read_b64_tr_b16 v[116:117], v5 offset:4192
    ds_read_b64_tr_b16 v[118:119], v5 offset:6240
    v_mfma_f32_16x16x32_bf16 v[48:51], v[88:91], v[8:11], 0
    v_mfma_f32_16x16x32_bf16 v[52:55], v[92:95], v[8:11], 0
    s_waitcnt lgkmcnt(8)
    v_mfma_f32_16x16x32_bf16 v[56:59], v[96:99], v[8:11], 0
    v_mfma_f32_16x16x32_bf16 v[60:63], v[100:103], v[8:11], 0
    s_waitcnt lgkmcnt(4)
    v_mfma_f32_16x16x32_bf16 v[48:51], v[104:107], v[12:15], v[48:51]
    v_mfma_f32_16x16x32_bf16 v[52:55], v[108:111], v[12:15], v[52:55]
    s_waitcnt lgkmcnt(0)
    v_mfma_f32_16x16x32_bf16 v[56:59], v[112:115], v[12:15], v[56:59]
    v_mfma_f32_16x16x32_bf16 v[60:63], v[116:119], v[12:15], v[60:63]
    s_mov_b32 s13, 0x40000
Lw_14:
    ds_read_b32 v3, v2 offset:5128
    s_waitcnt lgkmcnt(0)
    v_readfirstlane_b32 s12, v3
    s_nop 0
    s_cmp_ge_u32 s12, 16
    s_cbranch_scc1 Lwd_15
    s_sub_u32 s13, s13, 1
    s_cbranch_scc1 Lwd_15
    s_sleep 1
    s_branch Lw_14
Lwd_15:
    ds_read_b64_tr_b16 v[88:89], v5 offset:8192
    ds_read_b64_tr_b16 v[90:91], v5 offset:10240
    ds_read_b64_tr_b16 v[92:93], v5 offset:8224
    ds_read_b64_tr_b16 v[94:95], v5 offset:10272
    ds_read_b64_tr_b16 v[96:97], v5 offset:8256
    ds_read_b64_tr_b16 v[98:99], v5 offset:10304
    ds_read_b64_tr_b16 v[100:101], v5 offset:8288
    ds_read_b64_tr_b16 v[102:103], v5 offset:10336
    s_waitcnt lgkmcnt(4)
    ds_read_b64_tr_b16 v[104:105], v5 offset:12288
    ds_read_b64_tr_b16 v[106:107], v5 offset:14336
    ds_read_b64_tr_b16 v[108:109], v5 offset:12320
    ds_read_b64_tr_b16 v[110:111], v5 offset:14368
    ds_read_b64_tr_b16 v[112:113], v5 offset:12352
    ds_read_b64_tr_b16 v[114:115], v5 offset:14400
    ds_read_b64_tr_b16 v[116:117], v5 offset:12384
    ds_read_b64_tr_b16 v[118:119], v5 offset:14432
    v_mfma_f32_16x16x32_bf16 v[48:51], v[88:91], v[16:19], v[48:51]
    v_mfma_f32_16x16x32_bf16 v[52:55], v[92:95], v[16:19], v[52:55]
    s_waitcnt lgkmcnt(8)
    v_mfma_f32_16x16x32_bf16 v[56:59], v[96:99], v[16:19], v[56:59]
    v_mfma_f32_16x16x32_bf16 v[60:63], v[100:103], v[16:19], v[60:63]
    s_waitcnt lgkmcnt(4)
    v_mfma_f32_16x16x32_bf16 v[48:51], v[104:107], v[20:23], v[48:51]
    v_mfma_f32_16x16x32_bf16 v[52:55], v[108:111], v[20:23], v[52:55]
    s_waitcnt lgkmcnt(0)
    v_mfma_f32_16x16x32_bf16 v[56:59], v[112:115], v[20:23], v[56:59]
    v_mfma_f32_16x16x32_bf16 v[60:63], v[116:119], v[20:23], v[60:63]
    s_mov_b32 s13, 0x40000
Lw_16:
    ds_read_b32 v3, v2 offset:5128
    s_waitcnt lgkmcnt(0)
    v_readfirstlane_b32 s12, v3
    s_nop 0
    s_cmp_ge_u32 s12, 24
    s_cbranch_scc1 Lwd_17
    s_sub_u32 s13, s13, 1
    s_cbranch_scc1 Lwd_17
    s_sleep 1
    s_branch Lw_16
Lwd_17:
    ds_read_b64_tr_b16 v[88:89], v5 offset:16384
    ds_read_b64_tr_b16 v[90:91], v5 offset:18432
    ds_read_b64_tr_b16 v[92:93], v5 offset:16416
    ds_read_b64_tr_b16 v[94:95], v5 offset:18464
    ds_read_b64_tr_b16 v[96:97], v5 offset:16448
    ds_read_b64_tr_b16 v[98:99], v5 offset:18496
    ds_read_b64_tr_b16 v[100:101], v5 offset:16480
    ds_read_b64_tr_b16 v[102:103], v5 offset:18528
    s_waitcnt lgkmcnt(4)
    ds_read_b64_tr_b16 v[104:105], v5 offset:20480
    ds_read_b64_tr_b16 v[106:107], v5 offset:22528
    ds_read_b64_tr_b16 v[108:109], v5 offset:20512
    ds_read_b64_tr_b16 v[110:111], v5 offset:22560
    ds_read_b64_tr_b16 v[112:113], v5 offset:20544
    ds_read_b64_tr_b16 v[114:115], v5 offset:22592
    ds_read_b64_tr_b16 v[116:117], v5 offset:20576
    ds_read_b64_tr_b16 v[118:119], v5 offset:22624
    v_mfma_f32_16x16x32_bf16 v[48:51], v[88:91], v[24:27], v[48:51]
    v_mfma_f32_16x16x32_bf16 v[52:55], v[92:95], v[24:27], v[52:55]
    s_waitcnt lgkmcnt(8)
    v_mfma_f32_16x16x32_bf16 v[56:59], v[96:99], v[24:27], v[56:59]
    v_mfma_f32_16x16x32_bf16 v[60:63], v[100:103], v[24:27], v[60:63]
    s_waitcnt lgkmcnt(4)
    v_mfma_f32_16x16x32_bf16 v[48:51], v[104:107], v[28:31], v[48:51]
    v_mfma_f32_16x16x32_bf16 v[52:55], v[108:111], v[28:31], v[52:55]
    s_waitcnt lgkmcnt(0)
    v_mfma_f32_16x16x32_bf16 v[56:59], v[112:115], v[28:31], v[56:59]
    v_mfma_f32_16x16x32_bf16 v[60:63], v[116:119], v[28:31], v[60:63]
    s_mov_b32 s13, 0x40000
Lw_18:
    ds_read_b32 v3, v2 offset:5128
    s_waitcnt lgkmcnt(0)
    v_readfirstlane_b32 s12, v3
    s_nop 0
    s_cmp_ge_u32 s12, 32
    s_cbranch_scc1 Lwd_19
    s_sub_u32 s13, s13, 1
    s_cbranch_scc1 Lwd_19
    s_branch Lw_18
Lwd_19:
    ds_read_b64_tr_b16 v[88:89], v5 offset:24576
    ds_read_b64_tr_b16 v[90:91], v5 offset:26624
    ds_read_b64_tr_b16 v[92:93], v5 offset:24608
    ds_read_b64_tr_b16 v[94:95], v5 offset:26656
    ds_read_b64_tr_b16 v[96:97], v5 offset:24640
    ds_read_b64_tr_b16 v[98:99], v5 offset:26688
    ds_read_b64_tr_b16 v[100:101], v5 offset:24672
    ds_read_b64_tr_b16 v[102:103], v5 offset:26720
    s_waitcnt lgkmcnt(4)
    ds_read_b64_tr_b16 v[104:105], v5 offset:28672
    ds_read_b64_tr_b16 v[106:107], v5 offset:30720
    ds_read_b64_tr_b16 v[108:109], v5 offset:28704
    ds_read_b64_tr_b16 v[110:111], v5 offset:30752
    ds_read_b64_tr_b16 v[112:113], v5 offset:28736
    ds_read_b64_tr_b16 v[114:115], v5 offset:30784
    ds_read_b64_tr_b16 v[116:117], v5 offset:28768
    ds_read_b64_tr_b16 v[118:119], v5 offset:30816
    v_mfma_f32_16x16x32_bf16 v[48:51], v[88:91], v[32:35], v[48:51]
    v_mfma_f32_16x16x32_bf16 v[52:55], v[92:95], v[32:35], v[52:55]
    s_waitcnt lgkmcnt(8)
    v_mfma_f32_16x16x32_bf16 v[56:59], v[96:99], v[32:35], v[56:59]
    v_mfma_f32_16x16x32_bf16 v[60:63], v[100:103], v[32:35], v[60:63]
    s_waitcnt lgkmcnt(4)
    v_mfma_f32_16x16x32_bf16 v[48:51], v[104:107], v[36:39], v[48:51]
    v_mfma_f32_16x16x32_bf16 v[52:55], v[108:111], v[36:39], v[52:55]
    s_waitcnt lgkmcnt(0)
    v_mfma_f32_16x16x32_bf16 v[56:59], v[112:115], v[36:39], v[56:59]
    v_mfma_f32_16x16x32_bf16 v[60:63], v[116:119], v[36:39], v[60:63]
    s_nop 4
    v_cndmask_b32 v48, v48, v52, s[64:65]
    v_cndmask_b32 v49, v49, v53, s[64:65]
    v_cndmask_b32 v50, v50, v54, s[64:65]
    v_cndmask_b32 v51, v51, v55, s[64:65]
    v_cndmask_b32 v48, v48, v56, s[66:67]
    v_cndmask_b32 v49, v49, v57, s[66:67]
    v_cndmask_b32 v50, v50, v58, s[66:67]
    v_cndmask_b32 v51, v51, v59, s[66:67]
    v_cndmask_b32 v80, v48, v60, s[68:69]
    v_cndmask_b32 v81, v49, v61, s[68:69]
    v_cndmask_b32 v84, v50, v62, s[68:69]
    v_cndmask_b32 v85, v51, v63, s[68:69]
    buffer_store_dwordx4 v[80:83], v6, s[44:47], s10 offen
    buffer_store_dwordx4 v[84:87], v6, s[44:47], s10 offen offset:2048
    v_mov_b32 v100, v80
    v_mov_b32 v101, v81
    v_mov_b32 v102, v82
    v_mov_b32 v103, v83
    v_mov_b32 v104, v84
    v_mov_b32 v105, v85
    v_mov_b32 v106, v86
    v_mov_b32 v107, v87
    v_mov_b32 v98, v6
    s_mov_b32 s97, s11
    s_mov_b32 s96, 1
    v_mov_b32 v3, 1
    s_mov_b64 exec, 1
    ds_write_b32 v2, v3 offset:5120
    s_mov_b64 exec, -1
    s_branch L_Q_gather2
L_Q_gather:
    s_mov_b32 s96, 0
    s_mov_b32 s97, 0
    v_mov_b32 v98, 0
    s_waitcnt lgkmcnt(0)
    s_add_u32 s60, s62, 0x7f4a7c15
    s_addc_u32 s61, s63, 0x9e3779b9
    s_getreg_b32 s95, hwreg(HW_REG_XCC_ID)
    s_and_b32 s95, s95, 0xf
    s_lshl_b32 s12, s4, 9
    s_lshl_b32 s13, s5, 4
    s_add_u32 s12, s12, s13
    s_add_u32 s12, s12, 32768
    v_mov_b32 v108, s95
    v_mov_b32 v109, 0
    v_mov_b32 v110, s60
    v_mov_b32 v111, s61
    s_mov_b64 exec, 1
    buffer_store_dwordx4 v[108:111], v109, s[44:47], s12 offen sc1
    s_mov_b64 exec, -1
L_Q_gather2:
    s_lshl_b32 s10, s6, 16
    s_lshl_b32 s11, s4, 13
    s_add_u32 s10, s10, s11
    s_add_u32 s66, s10, 720896
    v_lshl_add_u32 v5, v0, 3, v2
    v_lshl_add_u32 v6, v0, 2, v2
    v_add_u32 v7, 4096, v4
    s_add_u32 s11, s42, 28
    s_mov_b32 s13, 0x40000
Lw_20:
    ds_read_b32 v3, v2 offset:5128
    s_waitcnt lgkmcnt(0)
    v_readfirstlane_b32 s12, v3
    s_nop 0
    s_cmp_ge_u32 s12, s11
    s_cbranch_scc1 Lwd_21
    s_sub_u32 s13, s13, 1
    s_cbranch_scc1 Lwd_21
    s_sleep 2
    s_branch Lw_20
Lwd_21:
    s_mov_b32 s13, 0x3fff
Lp_22:
    s_and_b32 s12, s13, 1
    s_cmp_lt_u32 s13, 16359
    s_cselect_b32 s12, s12, 0
    s_mul_i32 s12, s12, 2097152
    s_add_u32 s67, s12, s66
    buffer_load_dwordx4 v[8:11], v4, s[44:47], s67 offen offset:0 sc1
    buffer_load_dwordx4 v[12:15], v4, s[44:47], s67 offen offset:1024 sc1
    buffer_load_dwordx4 v[16:19], v4, s[44:47], s67 offen offset:2048 sc1
    buffer_load_dwordx4 v[20:23], v4, s[44:47], s67 offen offset:3072 sc1
    buffer_load_dwordx4 v[24:27], v7, s[44:47], s67 offen offset:0 sc1
    buffer_load_dwordx4 v[28:31], v7, s[44:47], s67 offen offset:1024 sc1
    buffer_load_dwordx4 v[32:35], v7, s[44:47], s67 offen offset:2048 sc1
    buffer_load_dwordx4 v[36:39], v7, s[44:47], s67 offen offset:3072 sc1
    s_waitcnt vmcnt(0)
    v_cmp_ne_u64 s[14:15], s[60:61], v[10:11]
    v_cmp_ne_u64 vcc, s[60:61], v[14:15]
    s_nop 0
    s_or_b64 s[14:15], s[14:15], vcc
    v_cmp_ne_u64 vcc, s[60:61], v[18:19]
    s_nop 0
    s_or_b64 s[14:15], s[14:15], vcc
    v_cmp_ne_u64 vcc, s[60:61], v[22:23]
    s_nop 0
    s_or_b64 s[14:15], s[14:15], vcc
    v_cmp_ne_u64 vcc, s[60:61], v[26:27]
    s_nop 0
    s_or_b64 s[14:15], s[14:15], vcc
    v_cmp_ne_u64 vcc, s[60:61], v[30:31]
    s_nop 0
    s_or_b64 s[14:15], s[14:15], vcc
    v_cmp_ne_u64 vcc, s[60:61], v[34:35]
    s_nop 0
    s_or_b64 s[14:15], s[14:15], vcc
    v_cmp_ne_u64 vcc, s[60:61], v[38:39]
    s_nop 0
    s_or_b64 s[14:15], s[14:15], vcc
    s_cmp_eq_u64 s[14:15], 0
    s_cbranch_scc1 Lpd_23
    s_sub_u32 s13, s13, 1
    s_cbranch_scc1 Lpd_23
    s_cmp_eq_u32 s13, 16375
    s_cbranch_scc0 Le_25
    s_cmp_eq_u32 s96, 0
    s_cbranch_scc1 Lf_26
    buffer_store_dwordx4 v[100:103], v98, s[44:47], s97 offen sc1
    buffer_store_dwordx4 v[104:107], v98, s[44:47], s97 offen offset:2048 sc1
    s_mov_b32 s96, 0
Lf_26:
Le_25:
    s_sleep 0
    s_branch Lp_22
Lpd_23:
    v_pk_add_f32 v[8:9], v[8:9], v[24:25]
    v_pk_add_f32 v[12:13], v[12:13], v[28:29]
    v_pk_add_f32 v[16:17], v[16:17], v[32:33]
    v_pk_add_f32 v[20:21], v[20:21], v[36:37]
    v_cvt_pk_bf16_f32 v40, v8, v9
    v_cvt_pk_bf16_f32 v41, v16, v17
    v_cvt_pk_bf16_f32 v42, v12, v13
    v_cvt_pk_bf16_f32 v43, v20, v21
    ds_write_b64 v5, v[40:41] offset:4096
    ds_write_b64 v5, v[42:43] offset:4608
    v_mov_b32 v3, 1
    s_mov_b64 exec, 1
    ds_write_b32 v2, v3 offset:5124
    s_mov_b64 exec, -1
    s_lshl_b32 s12, s4, 9
    s_add_u32 s12, s12, 32768
    s_mov_b32 exec_hi, 0
    buffer_load_dwordx4 v[108:111], v4, s[44:47], s12 offen sc1
    s_waitcnt vmcnt(0)
    v_cmp_ne_u64 s[14:15], s[60:61], v[110:111]
    v_cmp_ne_u32 vcc, s95, v108
    s_mov_b64 exec, -1
    s_or_b64 s[14:15], s[14:15], vcc
    s_cmp_eq_u64 s[14:15], 0
    s_cbranch_scc0 Lx_27
    s_mov_b32 s96, 0
    v_mov_b32 v3, 1
    s_mov_b64 exec, 1
    ds_write_b32 v2, v3 offset:5180
    s_mov_b64 exec, -1
Lx_27:
    s_lshl_b32 s10, s8, 12
    s_add_u32 s66, s10, 131072
    s_mov_b32 s10, 0x3fb8aa3b
    s_mov_b32 s13, 0x3fff
Lp_28:
    s_and_b32 s12, s13, 1
    s_cmp_lt_u32 s13, 16359
    s_cselect_b32 s12, s12, 0
    s_mul_i32 s12, s12, 2097152
    s_add_u32 s67, s12, s66
    buffer_load_dwordx4 v[8:11], v4, s[44:47], s67 offen offset:0 sc1
    buffer_load_dwordx4 v[12:15], v4, s[44:47], s67 offen offset:1024 sc1
    buffer_load_dwordx4 v[16:19], v4, s[44:47], s67 offen offset:2048 sc1
    buffer_load_dwordx4 v[20:23], v4, s[44:47], s67 offen offset:3072 sc1
    s_waitcnt vmcnt(0)
    v_cmp_ne_u64 s[14:15], s[60:61], v[10:11]
    v_cmp_ne_u64 vcc, s[60:61], v[14:15]
    s_nop 0
    s_or_b64 s[14:15], s[14:15], vcc
    v_cmp_ne_u64 vcc, s[60:61], v[18:19]
    s_nop 0
    s_or_b64 s[14:15], s[14:15], vcc
    v_cmp_ne_u64 vcc, s[60:61], v[22:23]
    s_nop 0
    s_or_b64 s[14:15], s[14:15], vcc
    s_cmp_eq_u64 s[14:15], 0
    s_cbranch_scc1 Lpd_29
    s_sub_u32 s13, s13, 1
    s_cbranch_scc1 Lpd_29
    s_cmp_eq_u32 s13, 16375
    s_cbranch_scc0 Le_31
    s_cmp_eq_u32 s96, 0
    s_cbranch_scc1 Lf_32
    buffer_store_dwordx4 v[100:103], v98, s[44:47], s97 offen sc1
    buffer_store_dwordx4 v[104:107], v98, s[44:47], s97 offen offset:2048 sc1
    s_mov_b32 s96, 0
Lf_32:
Le_31:
    s_sleep 0
    s_branch Lp_28
Lpd_29:
    v_max_f32 v24, v8, v12
    v_max3_f32 v24, v24, v16, v20
    s_nop 1
    v_max_f32_dpp v24, v24, v24 row_ror:4 row_mask:0xf bank_mask:0xf
    s_nop 1
    v_max_f32_dpp v24, v24, v24 row_ror:8 row_mask:0xf bank_mask:0xf
    v_mov_b32 v25, v24
    s_nop 1
    v_permlane16_swap_b32 v24, v25
    v_max_f32 v24, v24, v25
    v_mov_b32 v25, v24
    s_nop 1
    v_permlane32_swap_b32 v24, v25
    v_max_f32 v24, v24, v25
    v_sub_f32 v26, v8, v24
    v_sub_f32 v27, v12, v24
    v_sub_f32 v28, v16, v24
    v_sub_f32 v29, v20, v24
    v_mul_f32 v26, s10, v26
    v_mul_f32 v27, s10, v27
    v_mul_f32 v28, s10, v28
    v_mul_f32 v29, s10, v29
    v_exp_f32 v26, v26
    v_exp_f32 v27, v27
    v_exp_f32 v28, v28
    v_exp_f32 v29, v29
    v_mul_f32 v30, v26, v9
    v_fmac_f32 v30, v27, v13
    v_fmac_f32 v30, v28, v17
    v_fmac_f32 v30, v29, v21
    s_nop 1
    v_add_f32_dpp v30, v30, v30 row_ror:4 row_mask:0xf bank_mask:0xf
    s_nop 1
    v_add_f32_dpp v30, v30, v30 row_ror:8 row_mask:0xf bank_mask:0xf
    v_mov_b32 v25, v30
    s_nop 1
    v_permlane16_swap_b32 v30, v25
    v_add_f32 v30, v30, v25
    v_mov_b32 v25, v30
    s_nop 1
    v_permlane32_swap_b32 v30, v25
    v_add_f32 v30, v30, v25
    v_rcp_f32 v25, v30
    s_nop 0
    v_fma_f32 v31, -v30, v25, 1.0
    v_fmac_f32 v25, v31, v25
    s_mov_b64 exec, 15
    ds_write_b64 v5, v[24:25] offset:5376
    s_mov_b64 exec, -1
    v_mov_b32 v3, 1
    s_mov_b64 exec, 1
    ds_write_b32 v2, v3 offset:5140
    s_mov_b64 exec, -1
    s_cmp_eq_u32 s96, 0
    s_cbranch_scc1 Lf_33
    buffer_store_dwordx4 v[100:103], v98, s[44:47], s97 offen sc1
    buffer_store_dwordx4 v[104:107], v98, s[44:47], s97 offen offset:2048 sc1
    s_mov_b32 s96, 0
Lf_33:
    s_cmp_lg_u32 s4, 0
    s_cbranch_scc1 L_Q_done
    s_cmp_ge_u32 s5, 4
    s_cbranch_scc1 L_Q_done
    s_setprio 0
    s_mov_b32 s13, 0x40000
Lw_34:
    ds_read_b32 v3, v2 offset:5176
    s_waitcnt lgkmcnt(0)
    v_readfirstlane_b32 s12, v3
    s_nop 0
    s_cmp_ge_u32 s12, 4
    s_cbranch_scc1 Lwd_35
    s_sub_u32 s13, s13, 1
    s_cbranch_scc1 Lwd_35
    s_sleep 1
    s_branch Lw_34
Lwd_35:
    s_mov_b32 s66, 655360
    s_mov_b32 s67, 659456
    s_mov_b32 s13, 0x3fff
Lp_36:
    buffer_load_dwordx4 v[8:11], v4, s[44:47], s66 offen offset:0 sc1
    buffer_load_dwordx4 v[12:15], v4, s[44:47], s66 offen offset:1024 sc1
    buffer_load_dwordx4 v[16:19], v4, s[44:47], s66 offen offset:2048 sc1
    buffer_load_dwordx4 v[20:23], v4, s[44:47], s66 offen offset:3072 sc1
    buffer_load_dwordx4 v[24:27], v4, s[44:47], s67 offen offset:0 sc1
    buffer_load_dwordx4 v[28:31], v4, s[44:47], s67 offen offset:1024 sc1
    buffer_load_dwordx4 v[32:35], v4, s[44:47], s67 offen offset:2048 sc1
    buffer_load_dwordx4 v[36:39], v4, s[44:47], s67 offen offset:3072 sc1
    s_waitcnt vmcnt(0)
    v_cmp_ne_u64 s[14:15], s[60:61], v[10:11]
    v_cmp_ne_u64 vcc, s[60:61], v[14:15]
    s_nop 0
    s_or_b64 s[14:15], s[14:15], vcc
    v_cmp_ne_u64 vcc, s[60:61], v[18:19]
    s_nop 0
    s_or_b64 s[14:15], s[14:15], vcc
    v_cmp_ne_u64 vcc, s[60:61], v[22:23]
    s_nop 0
    s_or_b64 s[14:15], s[14:15], vcc
    v_cmp_ne_u64 vcc, s[60:61], v[26:27]
    s_nop 0
    s_or_b64 s[14:15], s[14:15], vcc
    v_cmp_ne_u64 vcc, s[60:61], v[30:31]
    s_nop 0
    s_or_b64 s[14:15], s[14:15], vcc
    v_cmp_ne_u64 vcc, s[60:61], v[34:35]
    s_nop 0
    s_or_b64 s[14:15], s[14:15], vcc
    v_cmp_ne_u64 vcc, s[60:61], v[38:39]
    s_nop 0
    s_or_b64 s[14:15], s[14:15], vcc
    s_cmp_eq_u64 s[14:15], 0
    s_cbranch_scc1 Lpd_37
    s_sub_u32 s13, s13, 1
    s_cbranch_scc1 Lpd_37
    s_sleep 4
    s_branch Lp_36
Lpd_37:
    ds_write_b64 v5, v[8:9] offset:16384
    ds_write_b64 v5, v[12:13] offset:16896
    ds_write_b64 v5, v[16:17] offset:17408
    ds_write_b64 v5, v[20:21] offset:17920
    ds_write_b64 v5, v[24:25] offset:18432
    ds_write_b64 v5, v[28:29] offset:18944
    ds_write_b64 v5, v[32:33] offset:19456
    ds_write_b64 v5, v[36:37] offset:19968
    s_mov_b32 s66, 663552
    s_mov_b32 s67, 667648
    s_mov_b32 s13, 0x3fff
Lp_39:
    buffer_load_dwordx4 v[8:11], v4, s[44:47], s66 offen offset:0 sc1
    buffer_load_dwordx4 v[12:15], v4, s[44:47], s66 offen offset:1024 sc1
    buffer_load_dwordx4 v[16:19], v4, s[44:47], s66 offen offset:2048 sc1
    buffer_load_dwordx4 v[20:23], v4, s[44:47], s66 offen offset:3072 sc1
    buffer_load_dwordx4 v[24:27], v4, s[44:47], s67 offen offset:0 sc1
    buffer_load_dwordx4 v[28:31], v4, s[44:47], s67 offen offset:1024 sc1
    buffer_load_dwordx4 v[32:35], v4, s[44:47], s67 offen offset:2048 sc1
    buffer_load_dwordx4 v[36:39], v4, s[44:47], s67 offen offset:3072 sc1
    s_waitcnt vmcnt(0)
    v_cmp_ne_u64 s[14:15], s[60:61], v[10:11]
    v_cmp_ne_u64 vcc, s[60:61], v[14:15]
    s_nop 0
    s_or_b64 s[14:15], s[14:15], vcc
    v_cmp_ne_u64 vcc, s[60:61], v[18:19]
    s_nop 0
    s_or_b64 s[14:15], s[14:15], vcc
    v_cmp_ne_u64 vcc, s[60:61], v[22:23]
    s_nop 0
    s_or_b64 s[14:15], s[14:15], vcc
    v_cmp_ne_u64 vcc, s[60:61], v[26:27]
    s_nop 0
    s_or_b64 s[14:15], s[14:15], vcc
    v_cmp_ne_u64 vcc, s[60:61], v[30:31]
    s_nop 0
    s_or_b64 s[14:15], s[14:15], vcc
    v_cmp_ne_u64 vcc, s[60:61], v[34:35]
    s_nop 0
    s_or_b64 s[14:15], s[14:15], vcc
    v_cmp_ne_u64 vcc, s[60:61], v[38:39]
    s_nop 0
    s_or_b64 s[14:15], s[14:15], vcc
    s_cmp_eq_u64 s[14:15], 0
    s_cbranch_scc1 Lpd_40
    s_sub_u32 s13, s13, 1
    s_cbranch_scc1 Lpd_40
    s_sleep 4
    s_branch Lp_39
Lpd_40:
    ds_write_b64 v5, v[8:9] offset:20480
    ds_write_b64 v5, v[12:13] offset:20992
    ds_write_b64 v5, v[16:17] offset:21504
    ds_write_b64 v5, v[20:21] offset:22016
    ds_write_b64 v5, v[24:25] offset:22528
    ds_write_b64 v5, v[28:29] offset:23040
    ds_write_b64 v5, v[32:33] offset:23552
    ds_write_b64 v5, v[36:37] offset:24064
    s_mov_b32 s64, s28
    s_and_b32 s65, s29, 0xffff
    s_mov_b32 s66, 3584
    s_mov_b32 s67, 0x20000
    s_mov_b32 s48, s30
    s_and_b32 s49, s31, 0xffff
    s_mov_b32 s50, 3584
    s_mov_b32 s51, 0x20000
    s_mov_b32 s52, s32
    s_and_b32 s53, s33, 0xffff
    s_mov_b32 s54, 3584
    s_mov_b32 s55, 0x20000
    v_lshlrev_b32 v6, 3, v0
    buffer_load_dwordx2 v[8:9], v6, s[64:67], 0 offen offset:0
    buffer_load_dwordx2 v[92:93], v6, s[48:51], 0 offen offset:0
    buffer_load_dwordx2 v[106:107], v6, s[52:55], 0 offen offset:0
    buffer_load_dwordx2 v[10:11], v6, s[64:67], 0 offen offset:512
    buffer_load_dwordx2 v[94:95], v6, s[48:51], 0 offen offset:512
    buffer_load_dwordx2 v[108:109], v6, s[52:55], 0 offen offset:512
    buffer_load_dwordx2 v[12:13], v6, s[64:67], 0 offen offset:1024
    buffer_load_dwordx2 v[96:97], v6, s[48:51], 0 offen offset:1024
    buffer_load_dwordx2 v[110:111], v6, s[52:55], 0 offen offset:1024
    buffer_load_dwordx2 v[14:15], v6, s[64:67], 0 offen offset:1536
    buffer_load_dwordx2 v[98:99], v6, s[48:51], 0 offen offset:1536
    buffer_load_dwordx2 v[112:113], v6, s[52:55], 0 offen offset:1536
    buffer_load_dwordx2 v[16:17], v6, s[64:67], 0 offen offset:2048
    buffer_load_dwordx2 v[100:101], v6, s[48:51], 0 offen offset:2048
    buffer_load_dwordx2 v[114:115], v6, s[52:55], 0 offen offset:2048
    buffer_load_dwordx2 v[18:19], v6, s[64:67], 0 offen offset:2560
    buffer_load_dwordx2 v[102:103], v6, s[48:51], 0 offen offset:2560
    buffer_load_dwordx2 v[116:117], v6, s[52:55], 0 offen offset:2560
    buffer_load_dwordx2 v[20:21], v6, s[64:67], 0 offen offset:3072
    buffer_load_dwordx2 v[104:105], v6, s[48:51], 0 offen offset:3072
    buffer_load_dwordx2 v[118:119], v6, s[52:55], 0 offen offset:3072
    s_mov_b32 s64, s34
    s_and_b32 s65, s35, 0xffff
    s_mov_b32 s66, 2
    s_mov_b32 s67, 0x20000
    v_mov_b32 v7, 0
    buffer_load_ushort v120, v7, s[64:67], 0 offen
    s_waitcnt vmcnt(0)
    v_lshlrev_b32 v64, 16, v8
    v_and_b32 v65, 0xffff0000, v8
    v_lshlrev_b32 v66, 16, v9
    v_and_b32 v67, 0xffff0000, v9
    v_lshlrev_b32 v68, 16, v10
    v_and_b32 v69, 0xffff0000, v10
    v_lshlrev_b32 v70, 16, v11
    v_and_b32 v71, 0xffff0000, v11
    v_lshlrev_b32 v72, 16, v12
    v_and_b32 v73, 0xffff0000, v12
    v_lshlrev_b32 v74, 16, v13
    v_and_b32 v75, 0xffff0000, v13
    v_lshlrev_b32 v76, 16, v14
    v_and_b32 v77, 0xffff0000, v14
    v_lshlrev_b32 v78, 16, v15
    v_and_b32 v79, 0xffff0000, v15
    v_lshlrev_b32 v80, 16, v16
    v_and_b32 v81, 0xffff0000, v16
    v_lshlrev_b32 v82, 16, v17
    v_and_b32 v83, 0xffff0000, v17
    v_lshlrev_b32 v84, 16, v18
    v_and_b32 v85, 0xffff0000, v18
    v_lshlrev_b32 v86, 16, v19
    v_and_b32 v87, 0xffff0000, v19
    v_lshlrev_b32 v88, 16, v20
    v_and_b32 v89, 0xffff0000, v20
    v_lshlrev_b32 v90, 16, v21
    v_and_b32 v91, 0xffff0000, v21
    v_lshlrev_b32 v120, 16, v120
    v_lshl_add_u32 v5, v0, 5, v2
    s_mov_b32 s10, 0x08000800
    s_mov_b32 s11, 0x39003900
    s_lshl_b32 s65, s5, 10
    s_setprio 3
    s_mov_b32 s13, 0x40000
Lw_42:
    ds_read_b32 v3, v2 offset:5156
    s_waitcnt lgkmcnt(0)
    v_readfirstlane_b32 s12, v3
    s_nop 0
    s_cmp_ge_u32 s12, 8
    s_cbranch_scc1 Lwd_43
    s_sub_u32 s13, s13, 1
    s_cbranch_scc1 Lwd_43
    s_branch Lw_42
Lwd_43:
    ds_read_b128 v[32:35], v5 offset:14336
    ds_read_b128 v[36:39], v5 offset:14352
    s_waitcnt lgkmcnt(0)
    v_readfirstlane_b32 s68, v32
    s_nop 0
    s_mov_b32 s69, s68
    v_pk_add_f32 v[46:47], v[32:33], s[68:69] neg_lo:[0,1] neg_hi:[0,1]
    v_pk_add_f32 v[48:49], v[34:35], s[68:69] neg_lo:[0,1] neg_hi:[0,1]
    v_pk_add_f32 v[50:51], v[36:37], s[68:69] neg_lo:[0,1] neg_hi:[0,1]
    v_pk_add_f32 v[52:53], v[38:39], s[68:69] neg_lo:[0,1] neg_hi:[0,1]
    v_pk_add_f32 v[54:55], v[46:47], v[48:49]
    v_pk_mul_f32 v[56:57], v[46:47], v[46:47]
    v_pk_add_f32 v[58:59], v[50:51], v[52:53]
    v_pk_fma_f32 v[56:57], v[48:49], v[48:49], v[56:57]
    v_pk_add_f32 v[54:55], v[54:55], v[58:59]
    v_pk_fma_f32 v[56:57], v[50:51], v[50:51], v[56:57]
    v_add_f32 v54, v54, v55
    v_pk_fma_f32 v[56:57], v[52:53], v[52:53], v[56:57]
    v_add_f32 v56, v56, v57
    v_add_f32_dpp v54, v54, v54 quad_perm:[1,0,3,2] row_mask:0xf bank_mask:0xf
    s_nop 0
    v_add_f32_dpp v56, v56, v56 quad_perm:[1,0,3,2] row_mask:0xf bank_mask:0xf
    v_add_f32_dpp v54, v54, v54 quad_perm:[2,3,0,1] row_mask:0xf bank_mask:0xf
    s_nop 0
    v_add_f32_dpp v56, v56, v56 quad_perm:[2,3,0,1] row_mask:0xf bank_mask:0xf
    v_add_f32_dpp v54, v54, v54 row_half_mirror row_mask:0xf bank_mask:0xf
    s_nop 0
    v_add_f32_dpp v56, v56, v56 row_half_mirror row_mask:0xf bank_mask:0xf
    v_add_f32_dpp v54, v54, v54 row_mirror row_mask:0xf bank_mask:0xf
    s_nop 0
    v_add_f32_dpp v56, v56, v56 row_mirror row_mask:0xf bank_mask:0xf
    v_mov_b32 v58, v54
    v_mov_b32 v59, v56
    s_nop 0
    v_permlane16_swap_b32 v54, v58
    v_permlane16_swap_b32 v56, v59
    v_add_f32 v54, v54, v58
    v_add_f32 v56, v56, v59
    v_mov_b32 v58, v54
    v_mov_b32 v59, v56
    s_nop 0
    v_permlane32_swap_b32 v54, v58
    v_permlane32_swap_b32 v56, v59
    v_add_f32 v54, v54, v58
    v_add_f32 v56, v56, v59
    v_mul_f32 v54, 0x3b000000, v54
    v_mul_f32 v56, 0x3b000000, v56
    v_fma_f32 v56, -v54, v54, v56
    v_max_f32 v56, 0, v56
    v_add_f32 v54, s68, v54
    v_cvt_pk_bf16_f32 v58, v54, v56
    v_and_b32 v56, 0xffff0000, v58
    v_lshlrev_b32 v54, 16, v58
    v_add_f32 v56, 0x3727c5ac, v56
    v_mov_b32 v55, v54
    v_cvt_pk_bf16_f32 v56, v56, v56
    v_pk_add_f32 v[46:47], v[32:33], v[54:55] neg_lo:[0,1] neg_hi:[0,1]
    v_pk_add_f32 v[48:49], v[34:35], v[54:55] neg_lo:[0,1] neg_hi:[0,1]
    v_lshlrev_b32 v56, 16, v56
    v_pk_add_f32 v[50:51], v[36:37], v[54:55] neg_lo:[0,1] neg_hi:[0,1]
    v_pk_add_f32 v[52:53], v[38:39], v[54:55] neg_lo:[0,1] neg_hi:[0,1]
    v_sqrt_f32 v56, v56
    v_cvt_pk_bf16_f32 v16, v46, v47
    v_cvt_pk_bf16_f32 v17, v48, v49
    v_cvt_pk_bf16_f32 v56, v56, v56
    v_cvt_pk_bf16_f32 v18, v50, v51
    v_cvt_pk_bf16_f32 v19, v52, v53
    v_lshlrev_b32 v56, 16, v56
    v_lshlrev_b32 v46, 16, v16
    v_and_b32 v47, 0xffff0000, v16
    v_lshlrev_b32 v48, 16, v17
    v_and_b32 v49, 0xffff0000, v17
    v_rcp_f32 v56, v56
    v_lshlrev_b32 v50, 16, v18
    v_and_b32 v51, 0xffff0000, v18
    v_lshlrev_b32 v52, 16, v19
    v_and_b32 v53, 0xffff0000, v19
    v_mov_b32 v57, v56
    v_pk_mul_f32 v[46:47], v[46:47], v[56:57]
    v_pk_mul_f32 v[48:49], v[48:49], v[56:57]
    v_pk_mul_f32 v[50:51], v[50:51], v[56:57]
    v_pk_mul_f32 v[52:53], v[52:53], v[56:57]
    v_cvt_pk_bf16_f32 v16, v46, v47
    v_cvt_pk_bf16_f32 v17, v48, v49
    v_cvt_pk_bf16_f32 v18, v50, v51
    v_cvt_pk_bf16_f32 v19, v52, v53
    v_lshlrev_b32 v24, 16, v16
    v_and_b32 v25, 0xffff0000, v16
    v_lshlrev_b32 v26, 16, v17
    v_and_b32 v27, 0xffff0000, v17
    v_lshlrev_b32 v28, 16, v18
    v_and_b32 v29, 0xffff0000, v18
    v_lshlrev_b32 v30, 16, v19
    v_and_b32 v31, 0xffff0000, v19
    v_pk_add_f32 v[54:55], v[24:25], v[26:27]
    v_pk_mul_f32 v[56:57], v[24:25], v[24:25]
    v_pk_add_f32 v[58:59], v[28:29], v[30:31]
    v_pk_fma_f32 v[56:57], v[26:27], v[26:27], v[56:57]
    v_pk_add_f32 v[54:55], v[54:55], v[58:59]
    v_pk_fma_f32 v[56:57], v[28:29], v[28:29], v[56:57]
    v_add_f32 v54, v54, v55
    v_pk_fma_f32 v[56:57], v[30:31], v[30:31], v[56:57]
    v_add_f32 v56, v56, v57
    v_add_f32_dpp v54, v54, v54 quad_perm:[1,0,3,2] row_mask:0xf bank_mask:0xf
    s_nop 0
    v_add_f32_dpp v56, v56, v56 quad_perm:[1,0,3,2] row_mask:0xf bank_mask:0xf
    v_add_f32_dpp v54, v54, v54 quad_perm:[2,3,0,1] row_mask:0xf bank_mask:0xf
    s_nop 0
    v_add_f32_dpp v56, v56, v56 quad_perm:[2,3,0,1] row_mask:0xf bank_mask:0xf
    v_add_f32_dpp v54, v54, v54 row_half_mirror row_mask:0xf bank_mask:0xf
    s_nop 0
    v_add_f32_dpp v56, v56, v56 row_half_mirror row_mask:0xf bank_mask:0xf
    v_add_f32_dpp v54, v54, v54 row_mirror row_mask:0xf bank_mask:0xf
    s_nop 0
    v_add_f32_dpp v56, v56, v56 row_mirror row_mask:0xf bank_mask:0xf
    v_mov_b32 v58, v54
    v_mov_b32 v59, v56
    s_nop 0
    v_permlane16_swap_b32 v54, v58
    v_permlane16_swap_b32 v56, v59
    v_add_f32 v54, v54, v58
    v_add_f32 v56, v56, v59
    v_mov_b32 v58, v54
    v_mov_b32 v59, v56
    s_nop 0
    v_permlane32_swap_b32 v54, v58
    v_permlane32_swap_b32 v56, v59
    v_add_f32 v54, v54, v58
    v_add_f32 v56, v56, v59
    v_mul_f32 v54, 0x3b000000, v54
    v_mul_f32 v56, 0x3b000000, v56
    v_fma_f32 v56, -v54, v54, v56
    v_max_f32 v56, 0, v56
    v_cvt_pk_bf16_f32 v58, v54, v56
    v_and_b32 v56, 0xffff0000, v58
    v_lshlrev_b32 v54, 16, v58
    v_add_f32 v56, 0x3727c5ac, v56
    v_mov_b32 v55, v54
    v_cvt_pk_bf16_f32 v56, v56, v56
    v_pk_add_f32 v[46:47], v[24:25], v[54:55] neg_lo:[0,1] neg_hi:[0,1]
    v_pk_add_f32 v[48:49], v[26:27], v[54:55] neg_lo:[0,1] neg_hi:[0,1]
    v_lshlrev_b32 v56, 16, v56
    v_pk_add_f32 v[50:51], v[28:29], v[54:55] neg_lo:[0,1] neg_hi:[0,1]
    v_pk_add_f32 v[52:53], v[30:31], v[54:55] neg_lo:[0,1] neg_hi:[0,1]
    v_sqrt_f32 v56, v56
    v_cvt_pk_bf16_f32 v16, v46, v47
    v_cvt_pk_bf16_f32 v17, v48, v49
    v_cvt_pk_bf16_f32 v56, v56, v56
    v_cvt_pk_bf16_f32 v18, v50, v51
    v_cvt_pk_bf16_f32 v19, v52, v53
    v_lshlrev_b32 v56, 16, v56
    v_lshlrev_b32 v46, 16, v16
    v_and_b32 v47, 0xffff0000, v16
    v_lshlrev_b32 v48, 16, v17
    v_and_b32 v49, 0xffff0000, v17
    v_rcp_f32 v56, v56
    v_lshlrev_b32 v50, 16, v18
    v_and_b32 v51, 0xffff0000, v18
    v_lshlrev_b32 v52, 16, v19
    v_and_b32 v53, 0xffff0000, v19
    v_mov_b32 v57, v56
    v_pk_mul_f32 v[46:47], v[46:47], v[56:57]
    v_pk_mul_f32 v[48:49], v[48:49], v[56:57]
    v_pk_mul_f32 v[50:51], v[50:51], v[56:57]
    v_pk_mul_f32 v[52:53], v[52:53], v[56:57]
    v_cvt_pk_bf16_f32 v16, v46, v47
    v_cvt_pk_bf16_f32 v17, v48, v49
    v_cvt_pk_bf16_f32 v18, v50, v51
    v_cvt_pk_bf16_f32 v19, v52, v53
    v_and_b32 v40, 0x7fff7fff, v16
    v_and_b32 v41, 0x7fff7fff, v17
    v_and_b32 v42, 0x7fff7fff, v18
    v_and_b32 v43, 0x7fff7fff, v19
    v_pk_sub_u16 v40, v40, s11
    v_pk_sub_u16 v41, v41, s11
    v_pk_sub_u16 v42, v42, s11
    v_pk_sub_u16 v43, v43, s11
    v_lshrrev_b32 v44, 4, v16
    v_lshrrev_b32 v45, 4, v17
    v_lshrrev_b32 v46, 4, v18
    v_lshrrev_b32 v47, 4, v19
    v_or3_b32 v3, v40, v41, v42
    v_and_b32 v44, s10, v44
    v_and_b32 v45, s10, v45
    v_and_b32 v46, s10, v46
    v_and_b32 v47, s10, v47
    v_or_b32 v3, v3, v43
    v_and_b32 v3, 0xf800f800, v3
    s_mov_b32 s12, 0x07ff07ff
    v_and_or_b32 v40, v40, s12, v44
    v_and_or_b32 v41, v41, s12, v45
    v_and_or_b32 v42, v42, s12, v46
    v_and_or_b32 v43, v43, s12, v47
    v_cmp_ne_u32 s[14:15], 0, v3
    v_and_b32 v44, 0xffff, v40
    v_lshrrev_b32 v40, 16, v40
    v_lshl_add_u32 v44, v44, 1, v2
    v_lshl_add_u32 v40, v40, 1, v2
    ds_read_u16 v48, v44 offset:16384
    ds_read_u16 v49, v40 offset:16384
    v_and_b32 v45, 0xffff, v41
    v_lshrrev_b32 v41, 16, v41
    v_lshl_add_u32 v45, v45, 1, v2
    v_lshl_add_u32 v41, v41, 1, v2
    ds_read_u16 v50, v45 offset:16384
    ds_read_u16 v51, v41 offset:16384
    v_and_b32 v46, 0xffff, v42
    v_lshrrev_b32 v42, 16, v42
    v_lshl_add_u32 v46, v46, 1, v2
    v_lshl_add_u32 v42, v42, 1, v2
    ds_read_u16 v52, v46 offset:16384
    ds_read_u16 v53, v42 offset:16384
    v_and_b32 v47, 0xffff, v43
    v_lshrrev_b32 v43, 16, v43
    v_lshl_add_u32 v47, v47, 1, v2
    v_lshl_add_u32 v43, v43, 1, v2
    ds_read_u16 v54, v47 offset:16384
    ds_read_u16 v55, v43 offset:16384
    s_cmp_eq_u64 s[14:15], 0
    s_waitcnt lgkmcnt(0)
    s_cbranch_scc0 L_Q_fb
L_Q_nofb:
    v_lshlrev_b32 v48, 16, v48
    v_lshlrev_b32 v49, 16, v49
    v_lshlrev_b32 v50, 16, v50
    v_lshlrev_b32 v51, 16, v51
    v_lshlrev_b32 v52, 16, v52
    v_lshlrev_b32 v53, 16, v53
    v_lshlrev_b32 v54, 16, v54
    v_lshlrev_b32 v55, 16, v55
    v_pk_add_f32 v[48:49], v[48:49], v[32:33]
    v_pk_add_f32 v[50:51], v[50:51], v[34:35]
    v_pk_add_f32 v[52:53], v[52:53], v[36:37]
    v_pk_add_f32 v[54:55], v[54:55], v[38:39]
    v_cvt_pk_bf16_f32 v16, v48, v49
    v_cvt_pk_bf16_f32 v17, v50, v51
    v_cvt_pk_bf16_f32 v18, v52, v53
    v_cvt_pk_bf16_f32 v19, v54, v55
    buffer_store_dwordx4 v[16:19], v4, s[56:59], s65 offen
    s_cmp_lg_u32 s5, 0
    s_cbranch_scc1 L_Q_done
    v_mov_b32 v8, s60
    v_mov_b32 v9, s61
    v_mov_b32 v10, 0
    s_mov_b64 exec, 1
    buffer_store_dwordx2 v[8:9], v10, s[44:47], 0 offen
    s_mov_b64 exec, -1
L_Q_done:
    s_endpgm
L_Q_fb:
    v_and_b32 v24, 0xffff, v16
    v_lshrrev_b32 v25, 16, v16
    v_and_b32 v26, 0xffff, v17
    v_lshrrev_b32 v27, 16, v17
    v_and_b32 v28, 0xffff, v18
    v_lshrrev_b32 v29, 16, v18
    v_and_b32 v30, 0xffff, v19
    v_lshrrev_b32 v31, 16, v19
    s_movk_i32 s10, 0x800
    v_mov_b32 v42, 0xc0135761
    v_mov_b32 v43, 0xc0135761
    v_mov_b32 v44, 1.0
    v_mov_b32 v45, 1.0
    s_mov_b32 s92, 0xbdd2d3e8
    s_mov_b32 s93, 0xbdd2d3e8
    v_and_b32 v46, 0x7fff, v24
    v_subrev_u32 v46, 14592, v46
    v_cmp_le_u32 s[94:95], s10, v46
Lfb_44:
    s_nop 0
    s_cmp_eq_u64 s[94:95], 0
    s_cbranch_scc1 Lfbd_45
    s_ff1_i32_b64 s96, s[94:95]
    s_bitset0_b64 s[94:95], s96
    s_mov_b32 m0, s96
    s_nop 1
    v_readlane_b32 s68, v24, m0
    s_call_b64 s[98:99], L_eval
    s_nop 3
    v_writelane_b32 v48, s68, m0
    s_branch Lfb_44
Lfbd_45:
    v_and_b32 v46, 0x7fff, v25
    v_subrev_u32 v46, 14592, v46
    v_cmp_le_u32 s[94:95], s10, v46
Lfb_46:
    s_nop 0
    s_cmp_eq_u64 s[94:95], 0
    s_cbranch_scc1 Lfbd_47
    s_ff1_i32_b64 s96, s[94:95]
    s_bitset0_b64 s[94:95], s96
    s_mov_b32 m0, s96
    s_nop 1
    v_readlane_b32 s68, v25, m0
    s_call_b64 s[98:99], L_eval
    s_nop 3
    v_writelane_b32 v49, s68, m0
    s_branch Lfb_46
Lfbd_47:
    v_and_b32 v46, 0x7fff, v26
    v_subrev_u32 v46, 14592, v46
    v_cmp_le_u32 s[94:95], s10, v46
Lfb_48:
    s_nop 0
    s_cmp_eq_u64 s[94:95], 0
    s_cbranch_scc1 Lfbd_49
    s_ff1_i32_b64 s96, s[94:95]
    s_bitset0_b64 s[94:95], s96
    s_mov_b32 m0, s96
    s_nop 1
    v_readlane_b32 s68, v26, m0
    s_call_b64 s[98:99], L_eval
    s_nop 3
    v_writelane_b32 v50, s68, m0
    s_branch Lfb_48
Lfbd_49:
    v_and_b32 v46, 0x7fff, v27
    v_subrev_u32 v46, 14592, v46
    v_cmp_le_u32 s[94:95], s10, v46
Lfb_50:
    s_nop 0
    s_cmp_eq_u64 s[94:95], 0
    s_cbranch_scc1 Lfbd_51
    s_ff1_i32_b64 s96, s[94:95]
    s_bitset0_b64 s[94:95], s96
    s_mov_b32 m0, s96
    s_nop 1
    v_readlane_b32 s68, v27, m0
    s_call_b64 s[98:99], L_eval
    s_nop 3
    v_writelane_b32 v51, s68, m0
    s_branch Lfb_50
Lfbd_51:
    v_and_b32 v46, 0x7fff, v28
    v_subrev_u32 v46, 14592, v46
    v_cmp_le_u32 s[94:95], s10, v46
Lfb_52:
    s_nop 0
    s_cmp_eq_u64 s[94:95], 0
    s_cbranch_scc1 Lfbd_53
    s_ff1_i32_b64 s96, s[94:95]
    s_bitset0_b64 s[94:95], s96
    s_mov_b32 m0, s96
    s_nop 1
    v_readlane_b32 s68, v28, m0
    s_call_b64 s[98:99], L_eval
    s_nop 3
    v_writelane_b32 v52, s68, m0
    s_branch Lfb_52
Lfbd_53:
    v_and_b32 v46, 0x7fff, v29
    v_subrev_u32 v46, 14592, v46
    v_cmp_le_u32 s[94:95], s10, v46
Lfb_54:
    s_nop 0
    s_cmp_eq_u64 s[94:95], 0
    s_cbranch_scc1 Lfbd_55
    s_ff1_i32_b64 s96, s[94:95]
    s_bitset0_b64 s[94:95], s96
    s_mov_b32 m0, s96
    s_nop 1
    v_readlane_b32 s68, v29, m0
    s_call_b64 s[98:99], L_eval
    s_nop 3
    v_writelane_b32 v53, s68, m0
    s_branch Lfb_54
Lfbd_55:
    v_and_b32 v46, 0x7fff, v30
    v_subrev_u32 v46, 14592, v46
    v_cmp_le_u32 s[94:95], s10, v46
Lfb_56:
    s_nop 0
    s_cmp_eq_u64 s[94:95], 0
    s_cbranch_scc1 Lfbd_57
    s_ff1_i32_b64 s96, s[94:95]
    s_bitset0_b64 s[94:95], s96
    s_mov_b32 m0, s96
    s_nop 1
    v_readlane_b32 s68, v30, m0
    s_call_b64 s[98:99], L_eval
    s_nop 3
    v_writelane_b32 v54, s68, m0
    s_branch Lfb_56
Lfbd_57:
    v_and_b32 v46, 0x7fff, v31
    v_subrev_u32 v46, 14592, v46
    v_cmp_le_u32 s[94:95], s10, v46
Lfb_58:
    s_nop 0
    s_cmp_eq_u64 s[94:95], 0
    s_cbranch_scc1 Lfbd_59
    s_ff1_i32_b64 s96, s[94:95]
    s_bitset0_b64 s[94:95], s96
    s_mov_b32 m0, s96
    s_nop 1
    v_readlane_b32 s68, v31, m0
    s_call_b64 s[98:99], L_eval
    s_nop 3
    v_writelane_b32 v55, s68, m0
    s_branch Lfb_58
Lfbd_59:
    s_nop 1
    s_branch L_Q_nofb
L_eval:
    s_nop 3
    s_lshl_b32 s68, s68, 16
    s_mov_b32 s69, s68
    v_mov_b32 v40, 0
    v_lshlrev_b32 v14, 16, v92
    v_and_b32 v15, 0xffff0000, v92
    v_lshlrev_b32 v62, 16, v93
    v_and_b32 v63, 0xffff0000, v93
    v_pk_mul_f32 v[8:9], v[64:65], s[68:69]
    v_pk_mul_f32 v[56:57], v[66:67], s[68:69]
    v_cvt_pk_bf16_f32 v10, v8, v9
    v_cvt_pk_bf16_f32 v58, v56, v57
    v_lshlrev_b32 v8, 16, v10
    v_and_b32 v9, 0xffff0000, v10
    v_lshlrev_b32 v56, 16, v58
    v_and_b32 v57, 0xffff0000, v58
    v_pk_add_f32 v[8:9], v[8:9], v[14:15]
    v_pk_add_f32 v[56:57], v[56:57], v[62:63]
    v_cvt_pk_bf16_f32 v10, v8, v9
    v_cvt_pk_bf16_f32 v58, v56, v57
    v_lshlrev_b32 v8, 16, v10
    v_and_b32 v9, 0xffff0000, v10
    v_lshlrev_b32 v56, 16, v58
    v_and_b32 v57, 0xffff0000, v58
    v_pk_mul_f32 v[10:11], v[8:9], v[8:9]
    v_pk_mul_f32 v[58:59], v[56:57], v[56:57]
    v_pk_fma_f32 v[10:11], v[10:11], s[92:93], v[42:43]
    v_pk_fma_f32 v[58:59], v[58:59], s[92:93], v[42:43]
    v_pk_mul_f32 v[10:11], v[10:11], v[8:9]
    v_pk_mul_f32 v[58:59], v[58:59], v[56:57]
    v_exp_f32 v10, v10
    v_exp_f32 v11, v11
    v_exp_f32 v58, v58
    v_exp_f32 v59, v59
    v_pk_add_f32 v[10:11], v[10:11], v[44:45]
    v_pk_add_f32 v[58:59], v[58:59], v[44:45]
    v_rcp_f32 v10, v10
    v_rcp_f32 v11, v11
    v_rcp_f32 v58, v58
    v_rcp_f32 v59, v59
    v_pk_mul_f32 v[10:11], v[10:11], v[8:9]
    v_pk_mul_f32 v[58:59], v[58:59], v[56:57]
    v_cvt_pk_bf16_f32 v12, v10, v11
    v_cvt_pk_bf16_f32 v60, v58, v59
    v_dot2_f32_bf16 v40, v12, v106, v40
    v_dot2_f32_bf16 v40, v60, v107, v40
    v_lshlrev_b32 v14, 16, v94
    v_and_b32 v15, 0xffff0000, v94
    v_lshlrev_b32 v62, 16, v95
    v_and_b32 v63, 0xffff0000, v95
    v_pk_mul_f32 v[8:9], v[68:69], s[68:69]
    v_pk_mul_f32 v[56:57], v[70:71], s[68:69]
    v_cvt_pk_bf16_f32 v10, v8, v9
    v_cvt_pk_bf16_f32 v58, v56, v57
    v_lshlrev_b32 v8, 16, v10
    v_and_b32 v9, 0xffff0000, v10
    v_lshlrev_b32 v56, 16, v58
    v_and_b32 v57, 0xffff0000, v58
    v_pk_add_f32 v[8:9], v[8:9], v[14:15]
    v_pk_add_f32 v[56:57], v[56:57], v[62:63]
    v_cvt_pk_bf16_f32 v10, v8, v9
    v_cvt_pk_bf16_f32 v58, v56, v57
    v_lshlrev_b32 v8, 16, v10
    v_and_b32 v9, 0xffff0000, v10
    v_lshlrev_b32 v56, 16, v58
    v_and_b32 v57, 0xffff0000, v58
    v_pk_mul_f32 v[10:11], v[8:9], v[8:9]
    v_pk_mul_f32 v[58:59], v[56:57], v[56:57]
    v_pk_fma_f32 v[10:11], v[10:11], s[92:93], v[42:43]
    v_pk_fma_f32 v[58:59], v[58:59], s[92:93], v[42:43]
    v_pk_mul_f32 v[10:11], v[10:11], v[8:9]
    v_pk_mul_f32 v[58:59], v[58:59], v[56:57]
    v_exp_f32 v10, v10
    v_exp_f32 v11, v11
    v_exp_f32 v58, v58
    v_exp_f32 v59, v59
    v_pk_add_f32 v[10:11], v[10:11], v[44:45]
    v_pk_add_f32 v[58:59], v[58:59], v[44:45]
    v_rcp_f32 v10, v10
    v_rcp_f32 v11, v11
    v_rcp_f32 v58, v58
    v_rcp_f32 v59, v59
    v_pk_mul_f32 v[10:11], v[10:11], v[8:9]
    v_pk_mul_f32 v[58:59], v[58:59], v[56:57]
    v_cvt_pk_bf16_f32 v12, v10, v11
    v_cvt_pk_bf16_f32 v60, v58, v59
    v_dot2_f32_bf16 v40, v12, v108, v40
    v_dot2_f32_bf16 v40, v60, v109, v40
    v_lshlrev_b32 v14, 16, v96
    v_and_b32 v15, 0xffff0000, v96
    v_lshlrev_b32 v62, 16, v97
    v_and_b32 v63, 0xffff0000, v97
    v_pk_mul_f32 v[8:9], v[72:73], s[68:69]
    v_pk_mul_f32 v[56:57], v[74:75], s[68:69]
    v_cvt_pk_bf16_f32 v10, v8, v9
    v_cvt_pk_bf16_f32 v58, v56, v57
    v_lshlrev_b32 v8, 16, v10
    v_and_b32 v9, 0xffff0000, v10
    v_lshlrev_b32 v56, 16, v58
    v_and_b32 v57, 0xffff0000, v58
    v_pk_add_f32 v[8:9], v[8:9], v[14:15]
    v_pk_add_f32 v[56:57], v[56:57], v[62:63]
    v_cvt_pk_bf16_f32 v10, v8, v9
    v_cvt_pk_bf16_f32 v58, v56, v57
    v_lshlrev_b32 v8, 16, v10
    v_and_b32 v9, 0xffff0000, v10
    v_lshlrev_b32 v56, 16, v58
    v_and_b32 v57, 0xffff0000, v58
    v_pk_mul_f32 v[10:11], v[8:9], v[8:9]
    v_pk_mul_f32 v[58:59], v[56:57], v[56:57]
    v_pk_fma_f32 v[10:11], v[10:11], s[92:93], v[42:43]
    v_pk_fma_f32 v[58:59], v[58:59], s[92:93], v[42:43]
    v_pk_mul_f32 v[10:11], v[10:11], v[8:9]
    v_pk_mul_f32 v[58:59], v[58:59], v[56:57]
    v_exp_f32 v10, v10
    v_exp_f32 v11, v11
    v_exp_f32 v58, v58
    v_exp_f32 v59, v59
    v_pk_add_f32 v[10:11], v[10:11], v[44:45]
    v_pk_add_f32 v[58:59], v[58:59], v[44:45]
    v_rcp_f32 v10, v10
    v_rcp_f32 v11, v11
    v_rcp_f32 v58, v58
    v_rcp_f32 v59, v59
    v_pk_mul_f32 v[10:11], v[10:11], v[8:9]
    v_pk_mul_f32 v[58:59], v[58:59], v[56:57]
    v_cvt_pk_bf16_f32 v12, v10, v11
    v_cvt_pk_bf16_f32 v60, v58, v59
    v_dot2_f32_bf16 v40, v12, v110, v40
    v_dot2_f32_bf16 v40, v60, v111, v40
    v_lshlrev_b32 v14, 16, v98
    v_and_b32 v15, 0xffff0000, v98
    v_lshlrev_b32 v62, 16, v99
    v_and_b32 v63, 0xffff0000, v99
    v_pk_mul_f32 v[8:9], v[76:77], s[68:69]
    v_pk_mul_f32 v[56:57], v[78:79], s[68:69]
    v_cvt_pk_bf16_f32 v10, v8, v9
    v_cvt_pk_bf16_f32 v58, v56, v57
    v_lshlrev_b32 v8, 16, v10
    v_and_b32 v9, 0xffff0000, v10
    v_lshlrev_b32 v56, 16, v58
    v_and_b32 v57, 0xffff0000, v58
    v_pk_add_f32 v[8:9], v[8:9], v[14:15]
    v_pk_add_f32 v[56:57], v[56:57], v[62:63]
    v_cvt_pk_bf16_f32 v10, v8, v9
    v_cvt_pk_bf16_f32 v58, v56, v57
    v_lshlrev_b32 v8, 16, v10
    v_and_b32 v9, 0xffff0000, v10
    v_lshlrev_b32 v56, 16, v58
    v_and_b32 v57, 0xffff0000, v58
    v_pk_mul_f32 v[10:11], v[8:9], v[8:9]
    v_pk_mul_f32 v[58:59], v[56:57], v[56:57]
    v_pk_fma_f32 v[10:11], v[10:11], s[92:93], v[42:43]
    v_pk_fma_f32 v[58:59], v[58:59], s[92:93], v[42:43]
    v_pk_mul_f32 v[10:11], v[10:11], v[8:9]
    v_pk_mul_f32 v[58:59], v[58:59], v[56:57]
    v_exp_f32 v10, v10
    v_exp_f32 v11, v11
    v_exp_f32 v58, v58
    v_exp_f32 v59, v59
    v_pk_add_f32 v[10:11], v[10:11], v[44:45]
    v_pk_add_f32 v[58:59], v[58:59], v[44:45]
    v_rcp_f32 v10, v10
    v_rcp_f32 v11, v11
    v_rcp_f32 v58, v58
    v_rcp_f32 v59, v59
    v_pk_mul_f32 v[10:11], v[10:11], v[8:9]
    v_pk_mul_f32 v[58:59], v[58:59], v[56:57]
    v_cvt_pk_bf16_f32 v12, v10, v11
    v_cvt_pk_bf16_f32 v60, v58, v59
    v_dot2_f32_bf16 v40, v12, v112, v40
    v_dot2_f32_bf16 v40, v60, v113, v40
    v_lshlrev_b32 v14, 16, v100
    v_and_b32 v15, 0xffff0000, v100
    v_lshlrev_b32 v62, 16, v101
    v_and_b32 v63, 0xffff0000, v101
    v_pk_mul_f32 v[8:9], v[80:81], s[68:69]
    v_pk_mul_f32 v[56:57], v[82:83], s[68:69]
    v_cvt_pk_bf16_f32 v10, v8, v9
    v_cvt_pk_bf16_f32 v58, v56, v57
    v_lshlrev_b32 v8, 16, v10
    v_and_b32 v9, 0xffff0000, v10
    v_lshlrev_b32 v56, 16, v58
    v_and_b32 v57, 0xffff0000, v58
    v_pk_add_f32 v[8:9], v[8:9], v[14:15]
    v_pk_add_f32 v[56:57], v[56:57], v[62:63]
    v_cvt_pk_bf16_f32 v10, v8, v9
    v_cvt_pk_bf16_f32 v58, v56, v57
    v_lshlrev_b32 v8, 16, v10
    v_and_b32 v9, 0xffff0000, v10
    v_lshlrev_b32 v56, 16, v58
    v_and_b32 v57, 0xffff0000, v58
    v_pk_mul_f32 v[10:11], v[8:9], v[8:9]
    v_pk_mul_f32 v[58:59], v[56:57], v[56:57]
    v_pk_fma_f32 v[10:11], v[10:11], s[92:93], v[42:43]
    v_pk_fma_f32 v[58:59], v[58:59], s[92:93], v[42:43]
    v_pk_mul_f32 v[10:11], v[10:11], v[8:9]
    v_pk_mul_f32 v[58:59], v[58:59], v[56:57]
    v_exp_f32 v10, v10
    v_exp_f32 v11, v11
    v_exp_f32 v58, v58
    v_exp_f32 v59, v59
    v_pk_add_f32 v[10:11], v[10:11], v[44:45]
    v_pk_add_f32 v[58:59], v[58:59], v[44:45]
    v_rcp_f32 v10, v10
    v_rcp_f32 v11, v11
    v_rcp_f32 v58, v58
    v_rcp_f32 v59, v59
    v_pk_mul_f32 v[10:11], v[10:11], v[8:9]
    v_pk_mul_f32 v[58:59], v[58:59], v[56:57]
    v_cvt_pk_bf16_f32 v12, v10, v11
    v_cvt_pk_bf16_f32 v60, v58, v59
    v_dot2_f32_bf16 v40, v12, v114, v40
    v_dot2_f32_bf16 v40, v60, v115, v40
    v_lshlrev_b32 v14, 16, v102
    v_and_b32 v15, 0xffff0000, v102
    v_lshlrev_b32 v62, 16, v103
    v_and_b32 v63, 0xffff0000, v103
    v_pk_mul_f32 v[8:9], v[84:85], s[68:69]
    v_pk_mul_f32 v[56:57], v[86:87], s[68:69]
    v_cvt_pk_bf16_f32 v10, v8, v9
    v_cvt_pk_bf16_f32 v58, v56, v57
    v_lshlrev_b32 v8, 16, v10
    v_and_b32 v9, 0xffff0000, v10
    v_lshlrev_b32 v56, 16, v58
    v_and_b32 v57, 0xffff0000, v58
    v_pk_add_f32 v[8:9], v[8:9], v[14:15]
    v_pk_add_f32 v[56:57], v[56:57], v[62:63]
    v_cvt_pk_bf16_f32 v10, v8, v9
    v_cvt_pk_bf16_f32 v58, v56, v57
    v_lshlrev_b32 v8, 16, v10
    v_and_b32 v9, 0xffff0000, v10
    v_lshlrev_b32 v56, 16, v58
    v_and_b32 v57, 0xffff0000, v58
    v_pk_mul_f32 v[10:11], v[8:9], v[8:9]
    v_pk_mul_f32 v[58:59], v[56:57], v[56:57]
    v_pk_fma_f32 v[10:11], v[10:11], s[92:93], v[42:43]
    v_pk_fma_f32 v[58:59], v[58:59], s[92:93], v[42:43]
    v_pk_mul_f32 v[10:11], v[10:11], v[8:9]
    v_pk_mul_f32 v[58:59], v[58:59], v[56:57]
    v_exp_f32 v10, v10
    v_exp_f32 v11, v11
    v_exp_f32 v58, v58
    v_exp_f32 v59, v59
    v_pk_add_f32 v[10:11], v[10:11], v[44:45]
    v_pk_add_f32 v[58:59], v[58:59], v[44:45]
    v_rcp_f32 v10, v10
    v_rcp_f32 v11, v11
    v_rcp_f32 v58, v58
    v_rcp_f32 v59, v59
    v_pk_mul_f32 v[10:11], v[10:11], v[8:9]
    v_pk_mul_f32 v[58:59], v[58:59], v[56:57]
    v_cvt_pk_bf16_f32 v12, v10, v11
    v_cvt_pk_bf16_f32 v60, v58, v59
    v_dot2_f32_bf16 v40, v12, v116, v40
    v_dot2_f32_bf16 v40, v60, v117, v40
    v_lshlrev_b32 v14, 16, v104
    v_and_b32 v15, 0xffff0000, v104
    v_lshlrev_b32 v62, 16, v105
    v_and_b32 v63, 0xffff0000, v105
    v_pk_mul_f32 v[8:9], v[88:89], s[68:69]
    v_pk_mul_f32 v[56:57], v[90:91], s[68:69]
    v_cvt_pk_bf16_f32 v10, v8, v9
    v_cvt_pk_bf16_f32 v58, v56, v57
    v_lshlrev_b32 v8, 16, v10
    v_and_b32 v9, 0xffff0000, v10
    v_lshlrev_b32 v56, 16, v58
    v_and_b32 v57, 0xffff0000, v58
    v_pk_add_f32 v[8:9], v[8:9], v[14:15]
    v_pk_add_f32 v[56:57], v[56:57], v[62:63]
    v_cvt_pk_bf16_f32 v10, v8, v9
    v_cvt_pk_bf16_f32 v58, v56, v57
    v_lshlrev_b32 v8, 16, v10
    v_and_b32 v9, 0xffff0000, v10
    v_lshlrev_b32 v56, 16, v58
    v_and_b32 v57, 0xffff0000, v58
    v_pk_mul_f32 v[10:11], v[8:9], v[8:9]
    v_pk_mul_f32 v[58:59], v[56:57], v[56:57]
    v_pk_fma_f32 v[10:11], v[10:11], s[92:93], v[42:43]
    v_pk_fma_f32 v[58:59], v[58:59], s[92:93], v[42:43]
    v_pk_mul_f32 v[10:11], v[10:11], v[8:9]
    v_pk_mul_f32 v[58:59], v[58:59], v[56:57]
    v_exp_f32 v10, v10
    v_exp_f32 v11, v11
    v_exp_f32 v58, v58
    v_exp_f32 v59, v59
    v_pk_add_f32 v[10:11], v[10:11], v[44:45]
    v_pk_add_f32 v[58:59], v[58:59], v[44:45]
    v_rcp_f32 v10, v10
    v_rcp_f32 v11, v11
    v_rcp_f32 v58, v58
    v_rcp_f32 v59, v59
    v_pk_mul_f32 v[10:11], v[10:11], v[8:9]
    v_pk_mul_f32 v[58:59], v[58:59], v[56:57]
    v_cvt_pk_bf16_f32 v12, v10, v11
    v_cvt_pk_bf16_f32 v60, v58, v59
    v_dot2_f32_bf16 v40, v12, v118, v40
    v_dot2_f32_bf16 v40, v60, v119, v40
    s_nop 2
    v_add_f32_dpp v40, v40, v40 quad_perm:[1,0,3,2] row_mask:0xf bank_mask:0xf
    s_nop 1
    v_add_f32_dpp v40, v40, v40 quad_perm:[2,3,0,1] row_mask:0xf bank_mask:0xf
    s_nop 1
    v_add_f32_dpp v40, v40, v40 row_half_mirror row_mask:0xf bank_mask:0xf
    s_nop 1
    v_add_f32_dpp v40, v40, v40 row_mirror row_mask:0xf bank_mask:0xf
    v_mov_b32 v41, v40
    s_nop 1
    v_permlane16_swap_b32 v40, v41
    v_add_f32 v40, v40, v41
    v_mov_b32 v41, v40
    s_nop 1
    v_permlane32_swap_b32 v40, v41
    v_add_f32 v40, v40, v41
    v_cvt_pk_bf16_f32 v40, v40, v40
    v_lshlrev_b32 v40, 16, v40
    v_add_f32 v40, v40, v120
    v_cvt_pk_bf16_f32 v40, v40, v40
    v_and_b32 v40, 0xffff, v40
    s_nop 0
    v_readfirstlane_b32 s68, v40
    s_setpc_b64 s[98:99]
L_roleT:
    s_sub_u32 s9, s3, 10
    s_mov_b32 s64, s34
    s_and_b32 s65, s35, 0xffff
    s_mov_b32 s66, 2
    s_mov_b32 s67, 0x20000
    v_mov_b32 v5, 0
    buffer_load_ushort v6, v5, s[64:67], 0 offen
    s_mov_b32 s13, 0x40000
Lw_60:
    ds_read_b32 v3, v2 offset:5172
    s_waitcnt lgkmcnt(0)
    v_readfirstlane_b32 s12, v3
    s_nop 0
    s_cmp_ge_u32 s12, 1
    s_cbranch_scc1 Lwd_61
    s_sub_u32 s13, s13, 1
    s_cbranch_scc1 Lwd_61
    s_sleep 1
    s_branch Lw_60
Lwd_61:
    v_lshl_add_u32 v4, v0, 3, v2
    ds_read_b64 v[80:81], v4 offset:6144
    ds_read_b64 v[94:95], v4 offset:10240
    ds_read_b64 v[82:83], v4 offset:6656
    ds_read_b64 v[96:97], v4 offset:10752
    ds_read_b64 v[84:85], v4 offset:7168
    ds_read_b64 v[98:99], v4 offset:11264
    ds_read_b64 v[86:87], v4 offset:7680
    ds_read_b64 v[100:101], v4 offset:11776
    ds_read_b64 v[88:89], v4 offset:8192
    ds_read_b64 v[102:103], v4 offset:12288
    ds_read_b64 v[90:91], v4 offset:8704
    ds_read_b64 v[104:105], v4 offset:12800
    ds_read_b64 v[92:93], v4 offset:9216
    ds_read_b64 v[106:107], v4 offset:13312
    s_waitcnt lgkmcnt(0)
    ds_read_b64 v[64:65], v4 offset:14336
    ds_read_b64 v[66:67], v4 offset:14848
    ds_read_b64 v[68:69], v4 offset:15360
    ds_read_b64 v[70:71], v4 offset:15872
    ds_read_b64 v[72:73], v4 offset:16384
    ds_read_b64 v[74:75], v4 offset:16896
    ds_read_b64 v[76:77], v4 offset:17408
    v_lshlrev_b32 v8, 16, v80
    v_and_b32 v9, 0xffff0000, v80
    v_lshlrev_b32 v36, 16, v94
    v_and_b32 v37, 0xffff0000, v94
    v_lshlrev_b32 v10, 16, v81
    v_and_b32 v11, 0xffff0000, v81
    v_lshlrev_b32 v38, 16, v95
    v_and_b32 v39, 0xffff0000, v95
    v_lshlrev_b32 v12, 16, v82
    v_and_b32 v13, 0xffff0000, v82
    v_lshlrev_b32 v40, 16, v96
    v_and_b32 v41, 0xffff0000, v96
    v_lshlrev_b32 v14, 16, v83
    v_and_b32 v15, 0xffff0000, v83
    v_lshlrev_b32 v42, 16, v97
    v_and_b32 v43, 0xffff0000, v97
    v_lshlrev_b32 v16, 16, v84
    v_and_b32 v17, 0xffff0000, v84
    v_lshlrev_b32 v44, 16, v98
    v_and_b32 v45, 0xffff0000, v98
    v_lshlrev_b32 v18, 16, v85
    v_and_b32 v19, 0xffff0000, v85
    v_lshlrev_b32 v46, 16, v99
    v_and_b32 v47, 0xffff0000, v99
    v_lshlrev_b32 v20, 16, v86
    v_and_b32 v21, 0xffff0000, v86
    v_lshlrev_b32 v48, 16, v100
    v_and_b32 v49, 0xffff0000, v100
    v_lshlrev_b32 v22, 16, v87
    v_and_b32 v23, 0xffff0000, v87
    v_lshlrev_b32 v50, 16, v101
    v_and_b32 v51, 0xffff0000, v101
    v_lshlrev_b32 v24, 16, v88
    v_and_b32 v25, 0xffff0000, v88
    v_lshlrev_b32 v52, 16, v102
    v_and_b32 v53, 0xffff0000, v102
    v_lshlrev_b32 v26, 16, v89
    v_and_b32 v27, 0xffff0000, v89
    v_lshlrev_b32 v54, 16, v103
    v_and_b32 v55, 0xffff0000, v103
    v_lshlrev_b32 v28, 16, v90
    v_and_b32 v29, 0xffff0000, v90
    v_lshlrev_b32 v56, 16, v104
    v_and_b32 v57, 0xffff0000, v104
    v_lshlrev_b32 v30, 16, v91
    v_and_b32 v31, 0xffff0000, v91
    v_lshlrev_b32 v58, 16, v105
    v_and_b32 v59, 0xffff0000, v105
    v_lshlrev_b32 v32, 16, v92
    v_and_b32 v33, 0xffff0000, v92
    v_lshlrev_b32 v60, 16, v106
    v_and_b32 v61, 0xffff0000, v106
    v_lshlrev_b32 v34, 16, v93
    v_and_b32 v35, 0xffff0000, v93
    v_lshlrev_b32 v62, 16, v107
    v_and_b32 v63, 0xffff0000, v107
    v_mov_b32 v80, 0xc0135761
    v_mov_b32 v81, 0xc0135761
    v_mov_b32 v82, 1.0
    v_mov_b32 v83, 1.0
    s_mov_b32 s92, 0xbdd2d3e8
    s_mov_b32 s93, 0xbdd2d3e8
    s_lshl_b32 s10, s2, 4
    s_lshl_b32 s11, s9, 2
    s_add_u32 s10, s10, s11
    s_lshr_b32 s11, s10, 11
    s_and_b32 s10, s10, 0x7ff
    s_add_u32 s10, s10, 14592
    s_lshl_b32 s10, s10, 16
    s_lshl_b32 s11, s11, 31
    s_or_b32 s68, s10, s11
    s_mov_b32 s69, s68
    s_mov_b32 s11, 0
    s_waitcnt lgkmcnt(0)
    s_add_u32 s60, s62, 0x7f4a7c15
    s_addc_u32 s61, s63, 0x9e3779b9
    v_mov_b32 v3, 1
    s_mov_b64 exec, 1
    ds_add_u32 v2, v3 offset:5176
    s_mov_b64 exec, -1
L_T_tab:
    v_mov_b32 v107, v106
    v_mov_b32 v106, v105
    v_mov_b32 v105, v104
    v_mov_b32 v104, 0
    v_pk_mul_f32 v[88:89], v[8:9], s[68:69]
    v_pk_mul_f32 v[96:97], v[10:11], s[68:69]
    v_cvt_pk_bf16_f32 v90, v88, v89
    v_cvt_pk_bf16_f32 v98, v96, v97
    v_lshlrev_b32 v88, 16, v90
    v_and_b32 v89, 0xffff0000, v90
    v_lshlrev_b32 v96, 16, v98
    v_and_b32 v97, 0xffff0000, v98
    v_pk_add_f32 v[88:89], v[88:89], v[36:37]
    v_pk_add_f32 v[96:97], v[96:97], v[38:39]
    v_cvt_pk_bf16_f32 v90, v88, v89
    v_cvt_pk_bf16_f32 v98, v96, v97
    v_lshlrev_b32 v88, 16, v90
    v_and_b32 v89, 0xffff0000, v90
    v_lshlrev_b32 v96, 16, v98
    v_and_b32 v97, 0xffff0000, v98
    v_pk_mul_f32 v[90:91], v[88:89], v[88:89]
    v_pk_mul_f32 v[98:99], v[96:97], v[96:97]
    v_pk_fma_f32 v[90:91], v[90:91], s[92:93], v[80:81]
    v_pk_fma_f32 v[98:99], v[98:99], s[92:93], v[80:81]
    v_pk_mul_f32 v[90:91], v[90:91], v[88:89]
    v_pk_mul_f32 v[98:99], v[98:99], v[96:97]
    v_exp_f32 v90, v90
    v_exp_f32 v91, v91
    v_exp_f32 v98, v98
    v_exp_f32 v99, v99
    v_pk_add_f32 v[90:91], v[90:91], v[82:83]
    v_pk_add_f32 v[98:99], v[98:99], v[82:83]
    v_rcp_f32 v90, v90
    v_rcp_f32 v91, v91
    v_rcp_f32 v98, v98
    v_rcp_f32 v99, v99
    v_pk_mul_f32 v[90:91], v[90:91], v[88:89]
    v_pk_mul_f32 v[98:99], v[98:99], v[96:97]
    v_cvt_pk_bf16_f32 v92, v90, v91
    v_cvt_pk_bf16_f32 v100, v98, v99
    v_dot2_f32_bf16 v104, v92, v64, v104
    v_dot2_f32_bf16 v104, v100, v65, v104
    v_pk_mul_f32 v[88:89], v[12:13], s[68:69]
    v_pk_mul_f32 v[96:97], v[14:15], s[68:69]
    v_cvt_pk_bf16_f32 v90, v88, v89
    v_cvt_pk_bf16_f32 v98, v96, v97
    v_lshlrev_b32 v88, 16, v90
    v_and_b32 v89, 0xffff0000, v90
    v_lshlrev_b32 v96, 16, v98
    v_and_b32 v97, 0xffff0000, v98
    v_pk_add_f32 v[88:89], v[88:89], v[40:41]
    v_pk_add_f32 v[96:97], v[96:97], v[42:43]
    v_cvt_pk_bf16_f32 v90, v88, v89
    v_cvt_pk_bf16_f32 v98, v96, v97
    v_lshlrev_b32 v88, 16, v90
    v_and_b32 v89, 0xffff0000, v90
    v_lshlrev_b32 v96, 16, v98
    v_and_b32 v97, 0xffff0000, v98
    v_pk_mul_f32 v[90:91], v[88:89], v[88:89]
    v_pk_mul_f32 v[98:99], v[96:97], v[96:97]
    v_pk_fma_f32 v[90:91], v[90:91], s[92:93], v[80:81]
    v_pk_fma_f32 v[98:99], v[98:99], s[92:93], v[80:81]
    v_pk_mul_f32 v[90:91], v[90:91], v[88:89]
    v_pk_mul_f32 v[98:99], v[98:99], v[96:97]
    v_exp_f32 v90, v90
    v_exp_f32 v91, v91
    v_exp_f32 v98, v98
    v_exp_f32 v99, v99
    v_pk_add_f32 v[90:91], v[90:91], v[82:83]
    v_pk_add_f32 v[98:99], v[98:99], v[82:83]
    v_rcp_f32 v90, v90
    v_rcp_f32 v91, v91
    v_rcp_f32 v98, v98
    v_rcp_f32 v99, v99
    v_pk_mul_f32 v[90:91], v[90:91], v[88:89]
    v_pk_mul_f32 v[98:99], v[98:99], v[96:97]
    v_cvt_pk_bf16_f32 v92, v90, v91
    v_cvt_pk_bf16_f32 v100, v98, v99
    v_dot2_f32_bf16 v104, v92, v66, v104
    v_dot2_f32_bf16 v104, v100, v67, v104
    v_pk_mul_f32 v[88:89], v[16:17], s[68:69]
    v_pk_mul_f32 v[96:97], v[18:19], s[68:69]
    v_cvt_pk_bf16_f32 v90, v88, v89
    v_cvt_pk_bf16_f32 v98, v96, v97
    v_lshlrev_b32 v88, 16, v90
    v_and_b32 v89, 0xffff0000, v90
    v_lshlrev_b32 v96, 16, v98
    v_and_b32 v97, 0xffff0000, v98
    v_pk_add_f32 v[88:89], v[88:89], v[44:45]
    v_pk_add_f32 v[96:97], v[96:97], v[46:47]
    v_cvt_pk_bf16_f32 v90, v88, v89
    v_cvt_pk_bf16_f32 v98, v96, v97
    v_lshlrev_b32 v88, 16, v90
    v_and_b32 v89, 0xffff0000, v90
    v_lshlrev_b32 v96, 16, v98
    v_and_b32 v97, 0xffff0000, v98
    v_pk_mul_f32 v[90:91], v[88:89], v[88:89]
    v_pk_mul_f32 v[98:99], v[96:97], v[96:97]
    v_pk_fma_f32 v[90:91], v[90:91], s[92:93], v[80:81]
    v_pk_fma_f32 v[98:99], v[98:99], s[92:93], v[80:81]
    v_pk_mul_f32 v[90:91], v[90:91], v[88:89]
    v_pk_mul_f32 v[98:99], v[98:99], v[96:97]
    v_exp_f32 v90, v90
    v_exp_f32 v91, v91
    v_exp_f32 v98, v98
    v_exp_f32 v99, v99
    v_pk_add_f32 v[90:91], v[90:91], v[82:83]
    v_pk_add_f32 v[98:99], v[98:99], v[82:83]
    v_rcp_f32 v90, v90
    v_rcp_f32 v91, v91
    v_rcp_f32 v98, v98
    v_rcp_f32 v99, v99
    v_pk_mul_f32 v[90:91], v[90:91], v[88:89]
    v_pk_mul_f32 v[98:99], v[98:99], v[96:97]
    v_cvt_pk_bf16_f32 v92, v90, v91
    v_cvt_pk_bf16_f32 v100, v98, v99
    v_dot2_f32_bf16 v104, v92, v68, v104
    v_dot2_f32_bf16 v104, v100, v69, v104
    v_pk_mul_f32 v[88:89], v[20:21], s[68:69]
    v_pk_mul_f32 v[96:97], v[22:23], s[68:69]
    v_cvt_pk_bf16_f32 v90, v88, v89
    v_cvt_pk_bf16_f32 v98, v96, v97
    v_lshlrev_b32 v88, 16, v90
    v_and_b32 v89, 0xffff0000, v90
    v_lshlrev_b32 v96, 16, v98
    v_and_b32 v97, 0xffff0000, v98
    v_pk_add_f32 v[88:89], v[88:89], v[48:49]
    v_pk_add_f32 v[96:97], v[96:97], v[50:51]
    v_cvt_pk_bf16_f32 v90, v88, v89
    v_cvt_pk_bf16_f32 v98, v96, v97
    v_lshlrev_b32 v88, 16, v90
    v_and_b32 v89, 0xffff0000, v90
    v_lshlrev_b32 v96, 16, v98
    v_and_b32 v97, 0xffff0000, v98
    v_pk_mul_f32 v[90:91], v[88:89], v[88:89]
    v_pk_mul_f32 v[98:99], v[96:97], v[96:97]
    v_pk_fma_f32 v[90:91], v[90:91], s[92:93], v[80:81]
    v_pk_fma_f32 v[98:99], v[98:99], s[92:93], v[80:81]
    v_pk_mul_f32 v[90:91], v[90:91], v[88:89]
    v_pk_mul_f32 v[98:99], v[98:99], v[96:97]
    v_exp_f32 v90, v90
    v_exp_f32 v91, v91
    v_exp_f32 v98, v98
    v_exp_f32 v99, v99
    v_pk_add_f32 v[90:91], v[90:91], v[82:83]
    v_pk_add_f32 v[98:99], v[98:99], v[82:83]
    v_rcp_f32 v90, v90
    v_rcp_f32 v91, v91
    v_rcp_f32 v98, v98
    v_rcp_f32 v99, v99
    v_pk_mul_f32 v[90:91], v[90:91], v[88:89]
    v_pk_mul_f32 v[98:99], v[98:99], v[96:97]
    v_cvt_pk_bf16_f32 v92, v90, v91
    v_cvt_pk_bf16_f32 v100, v98, v99
    v_dot2_f32_bf16 v104, v92, v70, v104
    v_dot2_f32_bf16 v104, v100, v71, v104
    v_pk_mul_f32 v[88:89], v[24:25], s[68:69]
    v_pk_mul_f32 v[96:97], v[26:27], s[68:69]
    v_cvt_pk_bf16_f32 v90, v88, v89
    v_cvt_pk_bf16_f32 v98, v96, v97
    v_lshlrev_b32 v88, 16, v90
    v_and_b32 v89, 0xffff0000, v90
    v_lshlrev_b32 v96, 16, v98
    v_and_b32 v97, 0xffff0000, v98
    v_pk_add_f32 v[88:89], v[88:89], v[52:53]
    v_pk_add_f32 v[96:97], v[96:97], v[54:55]
    v_cvt_pk_bf16_f32 v90, v88, v89
    v_cvt_pk_bf16_f32 v98, v96, v97
    v_lshlrev_b32 v88, 16, v90
    v_and_b32 v89, 0xffff0000, v90
    v_lshlrev_b32 v96, 16, v98
    v_and_b32 v97, 0xffff0000, v98
    v_pk_mul_f32 v[90:91], v[88:89], v[88:89]
    v_pk_mul_f32 v[98:99], v[96:97], v[96:97]
    v_pk_fma_f32 v[90:91], v[90:91], s[92:93], v[80:81]
    v_pk_fma_f32 v[98:99], v[98:99], s[92:93], v[80:81]
    v_pk_mul_f32 v[90:91], v[90:91], v[88:89]
    v_pk_mul_f32 v[98:99], v[98:99], v[96:97]
    v_exp_f32 v90, v90
    v_exp_f32 v91, v91
    v_exp_f32 v98, v98
    v_exp_f32 v99, v99
    v_pk_add_f32 v[90:91], v[90:91], v[82:83]
    v_pk_add_f32 v[98:99], v[98:99], v[82:83]
    v_rcp_f32 v90, v90
    v_rcp_f32 v91, v91
    v_rcp_f32 v98, v98
    v_rcp_f32 v99, v99
    v_pk_mul_f32 v[90:91], v[90:91], v[88:89]
    v_pk_mul_f32 v[98:99], v[98:99], v[96:97]
    v_cvt_pk_bf16_f32 v92, v90, v91
    v_cvt_pk_bf16_f32 v100, v98, v99
    v_dot2_f32_bf16 v104, v92, v72, v104
    v_dot2_f32_bf16 v104, v100, v73, v104
    v_pk_mul_f32 v[88:89], v[28:29], s[68:69]
    v_pk_mul_f32 v[96:97], v[30:31], s[68:69]
    v_cvt_pk_bf16_f32 v90, v88, v89
    v_cvt_pk_bf16_f32 v98, v96, v97
    v_lshlrev_b32 v88, 16, v90
    v_and_b32 v89, 0xffff0000, v90
    v_lshlrev_b32 v96, 16, v98
    v_and_b32 v97, 0xffff0000, v98
    v_pk_add_f32 v[88:89], v[88:89], v[56:57]
    v_pk_add_f32 v[96:97], v[96:97], v[58:59]
    v_cvt_pk_bf16_f32 v90, v88, v89
    v_cvt_pk_bf16_f32 v98, v96, v97
    v_lshlrev_b32 v88, 16, v90
    v_and_b32 v89, 0xffff0000, v90
    v_lshlrev_b32 v96, 16, v98
    v_and_b32 v97, 0xffff0000, v98
    v_pk_mul_f32 v[90:91], v[88:89], v[88:89]
    v_pk_mul_f32 v[98:99], v[96:97], v[96:97]
    v_pk_fma_f32 v[90:91], v[90:91], s[92:93], v[80:81]
    v_pk_fma_f32 v[98:99], v[98:99], s[92:93], v[80:81]
    v_pk_mul_f32 v[90:91], v[90:91], v[88:89]
    v_pk_mul_f32 v[98:99], v[98:99], v[96:97]
    v_exp_f32 v90, v90
    v_exp_f32 v91, v91
    v_exp_f32 v98, v98
    v_exp_f32 v99, v99
    v_pk_add_f32 v[90:91], v[90:91], v[82:83]
    v_pk_add_f32 v[98:99], v[98:99], v[82:83]
    v_rcp_f32 v90, v90
    v_rcp_f32 v91, v91
    v_rcp_f32 v98, v98
    v_rcp_f32 v99, v99
    v_pk_mul_f32 v[90:91], v[90:91], v[88:89]
    v_pk_mul_f32 v[98:99], v[98:99], v[96:97]
    v_cvt_pk_bf16_f32 v92, v90, v91
    v_cvt_pk_bf16_f32 v100, v98, v99
    v_dot2_f32_bf16 v104, v92, v74, v104
    v_dot2_f32_bf16 v104, v100, v75, v104
    v_pk_mul_f32 v[88:89], v[32:33], s[68:69]
    v_pk_mul_f32 v[96:97], v[34:35], s[68:69]
    v_cvt_pk_bf16_f32 v90, v88, v89
    v_cvt_pk_bf16_f32 v98, v96, v97
    v_lshlrev_b32 v88, 16, v90
    v_and_b32 v89, 0xffff0000, v90
    v_lshlrev_b32 v96, 16, v98
    v_and_b32 v97, 0xffff0000, v98
    v_pk_add_f32 v[88:89], v[88:89], v[60:61]
    v_pk_add_f32 v[96:97], v[96:97], v[62:63]
    v_cvt_pk_bf16_f32 v90, v88, v89
    v_cvt_pk_bf16_f32 v98, v96, v97
    v_lshlrev_b32 v88, 16, v90
    v_and_b32 v89, 0xffff0000, v90
    v_lshlrev_b32 v96, 16, v98
    v_and_b32 v97, 0xffff0000, v98
    v_pk_mul_f32 v[90:91], v[88:89], v[88:89]
    v_pk_mul_f32 v[98:99], v[96:97], v[96:97]
    v_pk_fma_f32 v[90:91], v[90:91], s[92:93], v[80:81]
    v_pk_fma_f32 v[98:99], v[98:99], s[92:93], v[80:81]
    v_pk_mul_f32 v[90:91], v[90:91], v[88:89]
    v_pk_mul_f32 v[98:99], v[98:99], v[96:97]
    v_exp_f32 v90, v90
    v_exp_f32 v91, v91
    v_exp_f32 v98, v98
    v_exp_f32 v99, v99
    v_pk_add_f32 v[90:91], v[90:91], v[82:83]
    v_pk_add_f32 v[98:99], v[98:99], v[82:83]
    v_rcp_f32 v90, v90
    v_rcp_f32 v91, v91
    v_rcp_f32 v98, v98
    v_rcp_f32 v99, v99
    v_pk_mul_f32 v[90:91], v[90:91], v[88:89]
    v_pk_mul_f32 v[98:99], v[98:99], v[96:97]
    v_cvt_pk_bf16_f32 v92, v90, v91
    v_cvt_pk_bf16_f32 v100, v98, v99
    v_dot2_f32_bf16 v104, v92, v76, v104
    v_dot2_f32_bf16 v104, v100, v77, v104
    s_add_u32 s68, s68, 0x10000
    s_mov_b32 s69, s68
    s_add_u32 s11, s11, 1
    s_cmp_lt_u32 s11, 4
    s_cbranch_scc1 L_T_tab
    s_nop 2
    v_add_f32_dpp v104, v104, v104 quad_perm:[1,0,3,2] row_mask:0xf bank_mask:0xf
    v_add_f32_dpp v105, v105, v105 quad_perm:[1,0,3,2] row_mask:0xf bank_mask:0xf
    v_add_f32_dpp v106, v106, v106 quad_perm:[1,0,3,2] row_mask:0xf bank_mask:0xf
    v_add_f32_dpp v107, v107, v107 quad_perm:[1,0,3,2] row_mask:0xf bank_mask:0xf
    v_add_f32_dpp v104, v104, v104 quad_perm:[2,3,0,1] row_mask:0xf bank_mask:0xf
    v_add_f32_dpp v105, v105, v105 quad_perm:[2,3,0,1] row_mask:0xf bank_mask:0xf
    v_add_f32_dpp v106, v106, v106 quad_perm:[2,3,0,1] row_mask:0xf bank_mask:0xf
    v_add_f32_dpp v107, v107, v107 quad_perm:[2,3,0,1] row_mask:0xf bank_mask:0xf
    v_add_f32_dpp v104, v104, v104 row_half_mirror row_mask:0xf bank_mask:0xf
    v_add_f32_dpp v105, v105, v105 row_half_mirror row_mask:0xf bank_mask:0xf
    v_add_f32_dpp v106, v106, v106 row_half_mirror row_mask:0xf bank_mask:0xf
    v_add_f32_dpp v107, v107, v107 row_half_mirror row_mask:0xf bank_mask:0xf
    v_add_f32_dpp v104, v104, v104 row_mirror row_mask:0xf bank_mask:0xf
    v_add_f32_dpp v105, v105, v105 row_mirror row_mask:0xf bank_mask:0xf
    v_add_f32_dpp v106, v106, v106 row_mirror row_mask:0xf bank_mask:0xf
    v_add_f32_dpp v107, v107, v107 row_mirror row_mask:0xf bank_mask:0xf
    v_mov_b32 v84, v104
    v_mov_b32 v85, v105
    v_mov_b32 v86, v106
    v_mov_b32 v87, v107
    v_permlane16_swap_b32 v104, v84
    v_permlane16_swap_b32 v105, v85
    v_permlane16_swap_b32 v106, v86
    v_permlane16_swap_b32 v107, v87
    v_add_f32 v104, v104, v84
    v_add_f32 v105, v105, v85
    v_add_f32 v106, v106, v86
    v_add_f32 v107, v107, v87
    v_mov_b32 v84, v104
    v_mov_b32 v85, v105
    v_mov_b32 v86, v106
    v_mov_b32 v87, v107
    v_permlane32_swap_b32 v104, v84
    v_permlane32_swap_b32 v105, v85
    v_permlane32_swap_b32 v106, v86
    v_permlane32_swap_b32 v107, v87
    v_add_f32 v104, v104, v84
    v_add_f32 v105, v105, v85
    v_add_f32 v106, v106, v86
    v_add_f32 v107, v107, v87
    v_cvt_pk_bf16_f32 v104, v104, v104
    v_lshlrev_b32 v104, 16, v104
    v_cvt_pk_bf16_f32 v105, v105, v105
    v_lshlrev_b32 v105, 16, v105
    v_cvt_pk_bf16_f32 v106, v106, v106
    v_lshlrev_b32 v106, 16, v106
    v_cvt_pk_bf16_f32 v107, v107, v107
    v_lshlrev_b32 v107, 16, v107
    s_waitcnt vmcnt(0)
    v_lshlrev_b32 v6, 16, v6
    v_add_f32 v104, v104, v6
    v_add_f32 v105, v105, v6
    v_add_f32 v106, v106, v6
    v_add_f32 v107, v107, v6
    v_cvt_pk_bf16_f32 v88, v107, v106
    v_cvt_pk_bf16_f32 v89, v105, v104
    v_mov_b32 v90, s60
    v_mov_b32 v91, s61
    s_lshl_b32 s10, s2, 2
    s_add_u32 s10, s10, s9
    s_lshl_b32 s10, s10, 4
    s_add_u32 s10, s10, 655360
    s_mov_b64 exec, 1
    buffer_store_dwordx4 v[88:91], v5, s[44:47], s10 offen sc1
    s_mov_b64 exec, -1
    s_endpgm
L_roleW:
    s_setprio 2
    s_sub_u32 s9, s3, 2
    s_mov_b32 s64, s16
    s_and_b32 s65, s17, 0xffff
    s_mov_b32 s66, 4096
    s_mov_b32 s67, 0x20000
    v_and_b32 v7, 31, v0
    v_lshlrev_b32 v7, 2, v7
    s_lshl_b32 s10, s6, 10
    s_lshl_b32 s11, s9, 7
    s_add_u32 s10, s10, s11
    buffer_load_dword v96, v7, s[64:67], s10 offen
    s_waitcnt lgkmcnt(0)
    s_add_u32 s60, s62, 0x7f4a7c15
    s_addc_u32 s61, s63, 0x9e3779b9
    v_and_b32 v4, 15, v0
    v_lshrrev_b32 v5, 4, v0
    v_xor_b32 v6, v4, v5
    v_lshlrev_b32 v6, 4, v6
    v_lshl_add_u32 v6, v4, 8, v6
    s_lshl_b32 s10, s9, 13
    v_add_u32 v8, s10, v6
    v_xor_b32 v9, 64, v8
    v_xor_b32 v10, 128, v8
    v_xor_b32 v11, 192, v8
    v_and_b32 v7, 3, v0
    v_lshlrev_b32 v12, 8, v7
    v_lshl_add_u32 v12, v5, 4, v12
    v_add_u32 v12, v12, v2
    v_mov_b32 v74, s60
    v_mov_b32 v75, s61
    s_lshl_b32 s64, s8, 15
    s_lshl_b32 s12, s7, 12
    s_add_u32 s64, s64, s12
    s_lshr_b32 s12, s9, 2
    s_lshl_b32 s12, s12, 11
    s_add_u32 s64, s64, s12
    s_and_b32 s12, s9, 3
    s_lshl_b32 s12, s12, 6
    s_add_u32 s64, s64, s12
    s_add_u32 s64, s64, 1048576
    s_lshl_b32 s65, s8, 12
    s_lshl_b32 s12, s7, 9
    s_add_u32 s65, s65, s12
    s_lshl_b32 s12, s9, 6
    s_add_u32 s65, s65, s12
    s_add_u32 s65, s65, 131072
    v_lshlrev_b32 v13, 4, v7
    v_add_u32 v15, s65, v13
    v_lshl_add_u32 v13, v5, 8, v13
    v_add_u32 v13, s64, v13
    v_bfe_u32 v14, v0, 2, 2
    v_cmp_eq_u32 s[64:65], 1, v14
    v_cmp_eq_u32 s[68:69], 2, v14
    v_add_u32 v14, 1024, v13
    v_cndmask_b32 v13, v13, v14, s[64:65]
    v_cndmask_b32 v13, v13, v15, s[68:69]
    v_lshlrev_b32 v14, 4, v0
    s_lshl_b32 s11, s9, 3
    s_add_u32 s11, s11, s42
    s_add_u32 s11, s11, 8
    s_mov_b32 s13, 0x40000
Lw_62:
    ds_read_b32 v3, v2 offset:5128
    s_waitcnt lgkmcnt(0)
    v_readfirstlane_b32 s12, v3
    s_nop 0
    s_cmp_ge_u32 s12, s11
    s_cbranch_scc1 Lwd_63
    s_sub_u32 s13, s13, 1
    s_cbranch_scc1 Lwd_63
    s_sleep 1
    s_branch Lw_62
Lwd_63:
    ds_read_b128 v[32:35], v8 offset:0
    ds_read_b128 v[36:39], v9 offset:0
    ds_read_b128 v[40:43], v10 offset:0
    ds_read_b128 v[44:47], v11 offset:0
    ds_read_b128 v[48:51], v8 offset:4096
    ds_read_b128 v[52:55], v9 offset:4096
    ds_read_b128 v[56:59], v10 offset:4096
    ds_read_b128 v[60:63], v11 offset:4096
    s_mov_b32 s13, 0x40000
Lw_64:
    ds_read_b32 v3, v2 offset:5124
    s_waitcnt lgkmcnt(0)
    v_readfirstlane_b32 s12, v3
    s_nop 0
    s_cmp_ge_u32 s12, 1
    s_cbranch_scc1 Lwd_65
    s_sub_u32 s13, s13, 1
    s_cbranch_scc1 Lwd_65
    s_sleep 1
    s_branch Lw_64
Lwd_65:
    ds_read_b128 v[16:19], v12 offset:4096
    ds_read_b128 v[20:23], v12 offset:4160
    ds_read_b128 v[24:27], v12 offset:4224
    ds_read_b128 v[28:31], v12 offset:4288
    v_mov_b32 v3, 1
    s_mov_b64 exec, 1
    ds_add_u32 v2, v3 offset:5144
    s_mov_b64 exec, -1
    s_mov_b32 s10, 0x3db504f3
    s_mov_b32 s11, 0x3fb8aa3b
    s_waitcnt lgkmcnt(4)
    v_mfma_f32_16x16x32_bf16 v[64:67], v[32:35], v[16:19], 0
    v_mfma_f32_16x16x32_bf16 v[68:71], v[48:51], v[16:19], 0
    s_waitcnt lgkmcnt(3)
    v_mfma_f32_16x16x32_bf16 v[64:67], v[36:39], v[20:23], v[64:67]
    v_mfma_f32_16x16x32_bf16 v[68:71], v[52:55], v[20:23], v[68:71]
    s_waitcnt lgkmcnt(2)
    v_mfma_f32_16x16x32_bf16 v[64:67], v[40:43], v[24:27], v[64:67]
    v_mfma_f32_16x16x32_bf16 v[68:71], v[56:59], v[24:27], v[68:71]
    s_waitcnt lgkmcnt(1)
    v_mfma_f32_16x16x32_bf16 v[64:67], v[44:47], v[28:31], v[64:67]
    v_mfma_f32_16x16x32_bf16 v[68:71], v[60:63], v[28:31], v[68:71]
    s_nop 6
    v_cvt_pk_bf16_f32 v80, v64, v65
    v_cvt_pk_bf16_f32 v81, v66, v67
    v_cvt_pk_bf16_f32 v82, v68, v69
    v_cvt_pk_bf16_f32 v83, v70, v71
    v_lshlrev_b32 v64, 16, v80
    v_and_b32 v65, 0xffff0000, v80
    v_lshlrev_b32 v66, 16, v81
    v_and_b32 v67, 0xffff0000, v81
    v_lshlrev_b32 v68, 16, v82
    v_and_b32 v69, 0xffff0000, v82
    v_lshlrev_b32 v70, 16, v83
    v_and_b32 v71, 0xffff0000, v83
    v_mul_f32 v64, s10, v64
    v_mul_f32 v65, s10, v65
    v_mul_f32 v66, s10, v66
    v_mul_f32 v67, s10, v67
    v_mul_f32 v68, s10, v68
    v_mul_f32 v69, s10, v69
    v_mul_f32 v70, s10, v70
    v_mul_f32 v71, s10, v71
    v_cvt_pk_bf16_f32 v72, v64, v65
    v_cvt_pk_bf16_f32 v73, v66, v67
    v_cvt_pk_bf16_f32 v76, v68, v69
    v_cvt_pk_bf16_f32 v77, v70, v71
    v_lshlrev_b32 v64, 16, v72
    v_and_b32 v65, 0xffff0000, v72
    v_lshlrev_b32 v66, 16, v73
    v_and_b32 v67, 0xffff0000, v73
    v_lshlrev_b32 v68, 16, v76
    v_and_b32 v69, 0xffff0000, v76
    v_lshlrev_b32 v70, 16, v77
    v_and_b32 v71, 0xffff0000, v77
    v_cndmask_b32 v72, v72, v76, s[64:65]
    v_cndmask_b32 v73, v73, v77, s[64:65]
    v_max3_f32 v84, v64, v65, v66
    v_max3_f32 v85, v67, v68, v69
    v_max3_f32 v84, v84, v70, v71
    v_max_f32 v84, v84, v85
    v_mov_b32 v88, v84
    s_nop 1
    v_permlane16_swap_b32 v84, v88
    v_max_f32 v84, v84, v88
    v_mov_b32 v88, v84
    s_nop 1
    v_permlane32_swap_b32 v84, v88
    v_max_f32 v84, v84, v88
    v_sub_f32 v64, v64, v84
    v_sub_f32 v65, v65, v84
    v_sub_f32 v66, v66, v84
    v_sub_f32 v67, v67, v84
    v_sub_f32 v68, v68, v84
    v_sub_f32 v69, v69, v84
    v_sub_f32 v70, v70, v84
    v_sub_f32 v71, v71, v84
    v_mul_f32 v64, s11, v64
    v_mul_f32 v65, s11, v65
    v_mul_f32 v66, s11, v66
    v_mul_f32 v67, s11, v67
    v_mul_f32 v68, s11, v68
    v_mul_f32 v69, s11, v69
    v_mul_f32 v70, s11, v70
    v_mul_f32 v71, s11, v71
    v_exp_f32 v64, v64
    v_exp_f32 v65, v65
    v_exp_f32 v66, v66
    v_exp_f32 v67, v67
    v_exp_f32 v68, v68
    v_exp_f32 v69, v69
    v_exp_f32 v70, v70
    v_exp_f32 v71, v71
    v_add_f32 v85, v64, v65
    v_add_f32 v88, v66, v67
    v_add_f32 v89, v68, v69
    v_add_f32 v90, v70, v71
    v_add_f32 v85, v85, v88
    v_add_f32 v89, v89, v90
    v_add_f32 v85, v85, v89
    v_mov_b32 v88, v85
    s_nop 1
    v_permlane16_swap_b32 v85, v88
    v_add_f32 v85, v85, v88
    v_mov_b32 v88, v85
    s_nop 1
    v_permlane32_swap_b32 v85, v88
    v_add_f32 v85, v85, v88
    v_cndmask_b32 v72, v72, v84, s[68:69]
    v_cndmask_b32 v73, v73, v85, s[68:69]
    s_mov_b32 exec_lo, 0x00ff0fff
    s_mov_b32 exec_hi, 0x00ff00ff
    s_mov_b32 s12, 2097152
    buffer_store_dwordx4 v[72:75], v13, s[44:47], 0 offen
    s_mov_b64 exec, -1
    v_mov_b32 v100, v72
    v_mov_b32 v101, v73
    v_mov_b32 v102, v74
    v_mov_b32 v103, v75
    s_mov_b32 s97, 2097152
    s_mov_b32 s96, 1
    s_lshl_b32 s10, s8, 15
    s_lshr_b32 s12, s7, 2
    s_lshl_b32 s12, s12, 14
    s_add_u32 s10, s10, s12
    s_lshl_b32 s12, s9, 11
    s_add_u32 s10, s10, s12
    s_add_u32 s66, s10, 1048576
    v_lshrrev_b32 v16, 2, v0
    v_lshlrev_b32 v17, 3, v7
    v_lshl_add_u32 v16, v16, 6, v17
    s_lshl_b32 s10, s9, 13
    s_add_u32 s10, s10, 65536
    v_add_u32 v17, s10, v16
    v_lshl_add_u32 v18, v7, 3, v2
    v_lshlrev_b32 v19, 7, v7
    v_lshl_add_u32 v19, v5, 4, v19
    s_lshl_b32 s10, s9, 9
    v_add3_u32 v19, v19, v2, s10
    s_lshl_b32 s64, s9, 3
    s_add_u32 s64, s64, s42
    s_add_u32 s64, s64, 72
    s_mov_b32 s13, 0x3fff
Lp_66:
    s_and_b32 s12, s13, 1
    s_cmp_lt_u32 s13, 16359
    s_cselect_b32 s12, s12, 0
    s_mul_i32 s12, s12, 2097152
    s_add_u32 s67, s12, s66
    buffer_load_dwordx4 v[20:23], v14, s[44:47], s67 offen offset:0 sc1
    buffer_load_dwordx4 v[24:27], v14, s[44:47], s67 offen offset:1024 sc1
    s_waitcnt vmcnt(0)
    v_cmp_ne_u64 s[14:15], s[60:61], v[22:23]
    v_cmp_ne_u64 vcc, s[60:61], v[26:27]
    s_nop 0
    s_or_b64 s[14:15], s[14:15], vcc
    s_cmp_eq_u64 s[14:15], 0
    s_cbranch_scc1 Lpd_67
    s_sub_u32 s13, s13, 1
    s_cbranch_scc1 Lpd_67
    s_cmp_eq_u32 s13, 16375
    s_cbranch_scc0 Le_69
    s_cmp_eq_u32 s96, 0
    s_cbranch_scc1 Lf_70
    ds_read_b32 v3, v2 offset:5180
    s_waitcnt lgkmcnt(0)
    v_readfirstlane_b32 s12, v3
    s_nop 0
    s_cmp_eq_u32 s12, 1
    s_cbranch_scc1 Lf_70
    s_mov_b32 exec_lo, 0x00ff0fff
    s_mov_b32 exec_hi, 0x00ff00ff
    buffer_store_dwordx4 v[100:103], v13, s[44:47], s97 offen sc1
    s_mov_b64 exec, -1
    s_mov_b32 s96, 0
Lf_70:
Le_69:
    s_mov_b32 s14, 2
Lps_68:
    s_sleep 1
    ds_read_b32 v3, v2 offset:5140
    s_waitcnt lgkmcnt(0)
    v_readfirstlane_b32 s12, v3
    s_nop 0
    s_cmp_lg_u32 s12, 0
    s_cbranch_scc1 Lp_66
    s_sub_u32 s14, s14, 1
    s_cbranch_scc0 Lps_68
    s_branch Lp_66
Lpd_67:
    v_lshlrev_b32 v28, 16, v20
    v_and_b32 v29, 0xffff0000, v20
    v_lshlrev_b32 v30, 16, v21
    v_and_b32 v31, 0xffff0000, v21
    v_lshlrev_b32 v32, 16, v24
    v_and_b32 v33, 0xffff0000, v24
    v_lshlrev_b32 v34, 16, v25
    v_and_b32 v35, 0xffff0000, v25
    v_max3_f32 v38, v28, v29, v30
    v_max3_f32 v39, v31, v32, v33
    v_max3_f32 v38, v38, v34, v35
    v_max_f32 v38, v38, v39
    v_sub_f32 v28, v28, v38
    v_sub_f32 v29, v29, v38
    v_sub_f32 v30, v30, v38
    v_sub_f32 v31, v31, v38
    v_sub_f32 v32, v32, v38
    v_sub_f32 v33, v33, v38
    v_sub_f32 v34, v34, v38
    v_sub_f32 v35, v35, v38
    v_mul_f32 v28, s11, v28
    v_mul_f32 v29, s11, v29
    v_mul_f32 v30, s11, v30
    v_mul_f32 v31, s11, v31
    v_mul_f32 v32, s11, v32
    v_mul_f32 v33, s11, v33
    v_mul_f32 v34, s11, v34
    v_mul_f32 v35, s11, v35
    v_exp_f32 v28, v28
    v_exp_f32 v29, v29
    v_exp_f32 v30, v30
    v_exp_f32 v31, v31
    v_exp_f32 v32, v32
    v_exp_f32 v33, v33
    v_exp_f32 v34, v34
    v_exp_f32 v35, v35
    s_mov_b32 s13, 0x40000
Lw_71:
    ds_read_b32 v3, v2 offset:5176
    s_waitcnt lgkmcnt(0)
    v_readfirstlane_b32 s12, v3
    s_nop 0
    s_cmp_ge_u32 s12, 4
    s_cbranch_scc1 Lwd_72
    s_sub_u32 s13, s13, 1
    s_cbranch_scc1 Lwd_72
    s_sleep 1
    s_branch Lw_71
Lwd_72:
    s_mov_b32 s13, 0x40000
Lw_73:
    ds_read_b32 v3, v2 offset:5128
    s_waitcnt lgkmcnt(0)
    v_readfirstlane_b32 s12, v3
    s_nop 0
    s_cmp_ge_u32 s12, s64
    s_cbranch_scc1 Lwd_74
    s_sub_u32 s13, s13, 1
    s_cbranch_scc1 Lwd_74
    s_sleep 1
    s_branch Lw_73
Lwd_74:
    ds_read_b64_tr_b16 v[56:57], v17 offset:0
    ds_read_b64_tr_b16 v[58:59], v17 offset:1024
    ds_read_b64_tr_b16 v[60:61], v17 offset:32
    ds_read_b64_tr_b16 v[62:63], v17 offset:1056
    ds_read_b64_tr_b16 v[64:65], v17 offset:2048
    ds_read_b64_tr_b16 v[66:67], v17 offset:3072
    ds_read_b64_tr_b16 v[68:69], v17 offset:2080
    ds_read_b64_tr_b16 v[70:71], v17 offset:3104
    ds_read_b64_tr_b16 v[72:73], v17 offset:4096
    ds_read_b64_tr_b16 v[74:75], v17 offset:5120
    ds_read_b64_tr_b16 v[76:77], v17 offset:4128
    ds_read_b64_tr_b16 v[78:79], v17 offset:5152
    s_waitcnt lgkmcnt(8)
    ds_read_b64_tr_b16 v[80:81], v17 offset:6144
    ds_read_b64_tr_b16 v[82:83], v17 offset:7168
    ds_read_b64_tr_b16 v[84:85], v17 offset:6176
    ds_read_b64_tr_b16 v[86:87], v17 offset:7200
    s_mov_b32 s13, 0x40000
Lw_75:
    ds_read_b32 v3, v2 offset:5140
    s_waitcnt lgkmcnt(0)
    v_readfirstlane_b32 s12, v3
    s_nop 0
    s_cmp_ge_u32 s12, 1
    s_cbranch_scc1 Lwd_76
    s_sub_u32 s13, s13, 1
    s_cbranch_scc1 Lwd_76
    s_cmp_eq_u32 s13, 261888
    s_cbranch_scc0 Le_77
    s_cmp_eq_u32 s96, 0
    s_cbranch_scc1 Lf_78
    ds_read_b32 v3, v2 offset:5180
    s_waitcnt lgkmcnt(0)
    v_readfirstlane_b32 s12, v3
    s_nop 0
    s_cmp_eq_u32 s12, 1
    s_cbranch_scc1 Lf_78
    s_mov_b32 exec_lo, 0x00ff0fff
    s_mov_b32 exec_hi, 0x00ff00ff
    buffer_store_dwordx4 v[100:103], v13, s[44:47], s97 offen sc1
    s_mov_b64 exec, -1
    s_mov_b32 s96, 0
Lf_78:
Le_77:
    s_branch Lw_75
Lwd_76:
    ds_read_b64 v[36:37], v18 offset:5376
    s_waitcnt lgkmcnt(0)
    v_sub_f32 v38, v38, v36
    v_mul_f32 v38, s11, v38
    v_exp_f32 v38, v38
    s_nop 0
    v_mul_f32 v38, v38, v37
    v_mov_b32 v39, v38
    v_pk_mul_f32 v[28:29], v[28:29], v[38:39]
    v_pk_mul_f32 v[30:31], v[30:31], v[38:39]
    v_pk_mul_f32 v[32:33], v[32:33], v[38:39]
    v_pk_mul_f32 v[34:35], v[34:35], v[38:39]
    v_cvt_pk_bf16_f32 v40, v28, v29
    v_cvt_pk_bf16_f32 v41, v30, v31
    v_cvt_pk_bf16_f32 v42, v32, v33
    v_cvt_pk_bf16_f32 v43, v34, v35
    s_nop 1
    v_mfma_f32_16x16x32_bf16 v[88:91], v[56:59], v[40:43], 0
    v_mfma_f32_16x16x32_bf16 v[92:95], v[60:63], v[40:43], 0
    v_mov_b32_dpp v44, v40 row_shl:4 row_mask:0xf bank_mask:0xf
    v_mov_b32_dpp v45, v41 row_shl:4 row_mask:0xf bank_mask:0xf
    v_mov_b32_dpp v46, v42 row_shl:4 row_mask:0xf bank_mask:0xf
    v_mov_b32_dpp v47, v43 row_shl:4 row_mask:0xf bank_mask:0xf
    s_nop 1
    v_mfma_f32_16x16x32_bf16 v[88:91], v[64:67], v[44:47], v[88:91]
    v_mfma_f32_16x16x32_bf16 v[92:95], v[68:71], v[44:47], v[92:95]
    v_mov_b32_dpp v48, v40 row_shl:8 row_mask:0xf bank_mask:0xf
    v_mov_b32_dpp v49, v41 row_shl:8 row_mask:0xf bank_mask:0xf
    v_mov_b32_dpp v50, v42 row_shl:8 row_mask:0xf bank_mask:0xf
    v_mov_b32_dpp v51, v43 row_shl:8 row_mask:0xf bank_mask:0xf
    s_nop 1
    v_mfma_f32_16x16x32_bf16 v[88:91], v[72:75], v[48:51], v[88:91]
    v_mfma_f32_16x16x32_bf16 v[92:95], v[76:79], v[48:51], v[92:95]
    v_mov_b32_dpp v52, v40 row_shl:12 row_mask:0xf bank_mask:0xf
    v_mov_b32_dpp v53, v41 row_shl:12 row_mask:0xf bank_mask:0xf
    v_mov_b32_dpp v54, v42 row_shl:12 row_mask:0xf bank_mask:0xf
    v_mov_b32_dpp v55, v43 row_shl:12 row_mask:0xf bank_mask:0xf
    s_nop 1
    v_mfma_f32_16x16x32_bf16 v[88:91], v[80:83], v[52:55], v[88:91]
    v_mfma_f32_16x16x32_bf16 v[92:95], v[84:87], v[52:55], v[92:95]
    v_lshl_add_u32 v20, v0, 3, v2
    v_and_b32 v21, 1, v4
    v_lshlrev_b32 v21, 10, v21
    v_lshl_add_u32 v21, v5, 13, v21
    v_bfe_u32 v22, v4, 1, 2
    v_lshl_add_u32 v21, v22, 8, v21
    v_lshrrev_b32 v22, 3, v4
    v_lshl_add_u32 v21, v22, 6, v21
    s_lshl_b32 s10, s4, 15
    s_and_b32 s11, s7, 3
    s_lshl_b32 s11, s11, 11
    s_add_u32 s10, s10, s11
    s_lshr_b32 s11, s7, 2
    s_lshl_b32 s11, s11, 7
    s_add_u32 s10, s10, s11
    s_lshl_b32 s11, s6, 4
    s_add_u32 s10, s10, s11
    s_add_u32 s10, s10, 262144
    s_add_u32 s11, s10, 2097152
    s_mov_b32 exec_lo, 0x000f000f
    s_mov_b32 exec_hi, 0x000f000f
    ds_write_b128 v19, v[88:91] offset:6144
    ds_write_b128 v19, v[92:95] offset:6208
    s_mov_b64 exec, -1
    v_mov_b32 v3, 1
    s_mov_b64 exec, 1
    ds_add_rtn_u32 v3, v2, v3 offset:5148
    s_mov_b64 exec, -1
    s_waitcnt lgkmcnt(0)
    v_readfirstlane_b32 s12, v3
    s_nop 0
    s_cmp_lg_u32 s12, 7
    s_cbranch_scc1 L_W_onot
    ds_read_b64 v[24:25], v20 offset:6144
    ds_read_b64 v[26:27], v20 offset:6656
    ds_read_b64 v[28:29], v20 offset:7168
    ds_read_b64 v[30:31], v20 offset:7680
    ds_read_b64 v[32:33], v20 offset:8192
    ds_read_b64 v[34:35], v20 offset:8704
    ds_read_b64 v[36:37], v20 offset:9216
    ds_read_b64 v[38:39], v20 offset:9728
    s_waitcnt lgkmcnt(0)
    v_pk_add_f32 v[24:25], v[24:25], v[26:27]
    v_pk_add_f32 v[28:29], v[28:29], v[30:31]
    v_pk_add_f32 v[32:33], v[32:33], v[34:35]
    v_pk_add_f32 v[36:37], v[36:37], v[38:39]
    v_mov_b32 v26, s60
    v_pk_add_f32 v[24:25], v[24:25], v[28:29]
    v_pk_add_f32 v[32:33], v[32:33], v[36:37]
    v_mov_b32 v27, s61
    v_pk_add_f32 v[24:25], v[24:25], v[32:33]
    buffer_store_dwordx4 v[24:27], v21, s[44:47], s10 offen
    v_mov_b32 v3, 1
    s_mov_b64 exec, 1
    ds_write_b32 v2, v3 offset:5168
    s_mov_b64 exec, -1
    ds_read_b32 v3, v2 offset:5180
    s_waitcnt lgkmcnt(0)
    v_readfirstlane_b32 s12, v3
    s_nop 0
    s_cmp_eq_u32 s12, 1
    s_cbranch_scc1 L_W_onot
    buffer_store_dwordx4 v[24:27], v21, s[44:47], s11 offen sc1
L_W_onot:
    s_cmp_lt_u32 s5, 16
    s_cbranch_scc1 L_W_qwg
    s_lshl_b32 s10, s4, 15
    s_lshl_b32 s11, s9, 12
    s_add_u32 s10, s10, s11
    s_add_u32 s66, s10, 262144
    s_lshl_b32 s10, s9, 12
    v_add_u32 v17, s10, v16
    v_lshlrev_b32 v22, 4, v4
    v_lshl_add_u32 v22, v5, 15, v22
    s_lshl_b32 s10, s4, 12
    s_sub_u32 s11, s5, 16
    s_lshl_b32 s11, s11, 8
    s_add_u32 s10, s10, s11
    s_add_u32 s65, s10, 524288
    s_mov_b32 s13, 0x40000
Lw_79:
    ds_read_b32 v3, v2 offset:5128
    s_waitcnt lgkmcnt(0)
    v_readfirstlane_b32 s12, v3
    s_nop 0
    s_cmp_ge_u32 s12, 160
    s_cbranch_scc1 Lwd_80
    s_sub_u32 s13, s13, 1
    s_cbranch_scc1 Lwd_80
    s_sleep 1
    s_branch Lw_79
Lwd_80:
    ds_read_b64_tr_b16 v[56:57], v17 offset:0
    ds_read_b64_tr_b16 v[58:59], v17 offset:1024
    ds_read_b64_tr_b16 v[60:61], v17 offset:32
    ds_read_b64_tr_b16 v[62:63], v17 offset:1056
    ds_read_b64_tr_b16 v[64:65], v17 offset:2048
    ds_read_b64_tr_b16 v[66:67], v17 offset:3072
    ds_read_b64_tr_b16 v[68:69], v17 offset:2080
    ds_read_b64_tr_b16 v[70:71], v17 offset:3104
    s_mov_b32 s13, 0x40000
Lw_81:
    ds_read_b32 v3, v2 offset:5168
    s_waitcnt lgkmcnt(0)
    v_readfirstlane_b32 s12, v3
    s_nop 0
    s_cmp_ge_u32 s12, 1
    s_cbranch_scc1 Lwd_82
    s_sub_u32 s13, s13, 1
    s_cbranch_scc1 Lwd_82
    s_cmp_eq_u32 s13, 261888
    s_cbranch_scc0 Le_83
    s_cmp_eq_u32 s96, 0
    s_cbranch_scc1 Lf_84
    ds_read_b32 v3, v2 offset:5180
    s_waitcnt lgkmcnt(0)
    v_readfirstlane_b32 s12, v3
    s_nop 0
    s_cmp_eq_u32 s12, 1
    s_cbranch_scc1 Lf_84
    s_mov_b32 exec_lo, 0x00ff0fff
    s_mov_b32 exec_hi, 0x00ff00ff
    buffer_store_dwordx4 v[100:103], v13, s[44:47], s97 offen sc1
    s_mov_b64 exec, -1
    s_mov_b32 s96, 0
Lf_84:
Le_83:
    s_sleep 1
    s_branch Lw_81
Lwd_82:
    s_mov_b32 s13, 0x3fff
Lp_85:
    s_and_b32 s12, s13, 1
    s_cmp_lt_u32 s13, 16359
    s_cselect_b32 s12, s12, 0
    s_mul_i32 s12, s12, 2097152
    s_add_u32 s67, s12, s66
    buffer_load_dwordx4 v[24:27], v14, s[44:47], s67 offen offset:0 sc1
    buffer_load_dwordx4 v[28:31], v14, s[44:47], s67 offen offset:1024 sc1
    buffer_load_dwordx4 v[32:35], v14, s[44:47], s67 offen offset:2048 sc1
    buffer_load_dwordx4 v[36:39], v14, s[44:47], s67 offen offset:3072 sc1
    s_waitcnt vmcnt(0)
    v_cmp_ne_u64 s[14:15], s[60:61], v[26:27]
    v_cmp_ne_u64 vcc, s[60:61], v[30:31]
    s_nop 0
    s_or_b64 s[14:15], s[14:15], vcc
    v_cmp_ne_u64 vcc, s[60:61], v[34:35]
    s_nop 0
    s_or_b64 s[14:15], s[14:15], vcc
    v_cmp_ne_u64 vcc, s[60:61], v[38:39]
    s_nop 0
    s_or_b64 s[14:15], s[14:15], vcc
    s_cmp_eq_u64 s[14:15], 0
    s_cbranch_scc1 Lpd_86
    s_sub_u32 s13, s13, 1
    s_cbranch_scc1 Lpd_86
    s_cmp_eq_u32 s13, 16375
    s_cbranch_scc0 Le_88
    s_cmp_eq_u32 s96, 0
    s_cbranch_scc1 Lf_89
    ds_read_b32 v3, v2 offset:5180
    s_waitcnt lgkmcnt(0)
    v_readfirstlane_b32 s12, v3
    s_nop 0
    s_cmp_eq_u32 s12, 1
    s_cbranch_scc1 Lf_89
    s_mov_b32 exec_lo, 0x00ff0fff
    s_mov_b32 exec_hi, 0x00ff00ff
    buffer_store_dwordx4 v[100:103], v13, s[44:47], s97 offen sc1
    s_mov_b64 exec, -1
    s_mov_b32 s96, 0
Lf_89:
Le_88:
    s_sleep 0
    s_branch Lp_85
Lpd_86:
    v_add_f32_dpp v24, v24, v24 row_ror:8 row_mask:0xf bank_mask:0xf
    v_add_f32_dpp v25, v25, v25 row_ror:8 row_mask:0xf bank_mask:0xf
    v_add_f32_dpp v28, v28, v28 row_ror:8 row_mask:0xf bank_mask:0xf
    v_add_f32_dpp v29, v29, v29 row_ror:8 row_mask:0xf bank_mask:0xf
    v_add_f32_dpp v32, v32, v32 row_ror:8 row_mask:0xf bank_mask:0xf
    v_add_f32_dpp v33, v33, v33 row_ror:8 row_mask:0xf bank_mask:0xf
    v_add_f32_dpp v36, v36, v36 row_ror:8 row_mask:0xf bank_mask:0xf
    v_add_f32_dpp v37, v37, v37 row_ror:8 row_mask:0xf bank_mask:0xf
    v_cvt_pk_bf16_f32 v40, v24, v25
    v_cvt_pk_bf16_f32 v41, v28, v29
    v_cvt_pk_bf16_f32 v44, v32, v33
    v_cvt_pk_bf16_f32 v45, v36, v37
    v_mov_b32_dpp v42, v40 row_shl:4 row_mask:0xf bank_mask:0xf
    v_mov_b32_dpp v43, v41 row_shl:4 row_mask:0xf bank_mask:0xf
    v_mov_b32_dpp v46, v44 row_shl:4 row_mask:0xf bank_mask:0xf
    v_mov_b32_dpp v47, v45 row_shl:4 row_mask:0xf bank_mask:0xf
    v_mfma_f32_16x16x32_bf16 v[88:91], v[56:59], v[40:43], 0
    v_mfma_f32_16x16x32_bf16 v[92:95], v[60:63], v[40:43], 0
    v_mfma_f32_16x16x32_bf16 v[88:91], v[64:67], v[44:47], v[88:91]
    v_mfma_f32_16x16x32_bf16 v[92:95], v[68:71], v[44:47], v[92:95]
    s_mov_b32 exec_lo, 0x000f000f
    s_mov_b32 exec_hi, 0x000f000f
    s_nop 4
    ds_write_b128 v19, v[88:91] offset:10240
    ds_write_b128 v19, v[92:95] offset:10304
    s_mov_b64 exec, -1
    v_mov_b32 v3, 1
    s_mov_b64 exec, 1
    ds_add_rtn_u32 v3, v2, v3 offset:5152
    s_mov_b64 exec, -1
    s_waitcnt lgkmcnt(0)
    v_readfirstlane_b32 s12, v3
    s_nop 0
    s_cmp_lg_u32 s12, 7
    s_cbranch_scc1 L_W_done
    ds_read_b64 v[24:25], v20 offset:10240
    ds_read_b64 v[26:27], v20 offset:10752
    ds_read_b64 v[28:29], v20 offset:11264
    ds_read_b64 v[30:31], v20 offset:11776
    ds_read_b64 v[32:33], v20 offset:12288
    ds_read_b64 v[34:35], v20 offset:12800
    ds_read_b64 v[36:37], v20 offset:13312
    ds_read_b64 v[38:39], v20 offset:13824
    s_waitcnt lgkmcnt(0)
    v_pk_add_f32 v[24:25], v[24:25], v[26:27]
    v_pk_add_f32 v[28:29], v[28:29], v[30:31]
    v_pk_add_f32 v[32:33], v[32:33], v[34:35]
    v_pk_add_f32 v[36:37], v[36:37], v[38:39]
    v_mov_b32 v26, s60
    v_pk_add_f32 v[24:25], v[24:25], v[28:29]
    v_pk_add_f32 v[32:33], v[32:33], v[36:37]
    v_mov_b32 v27, s61
    v_pk_add_f32 v[24:25], v[24:25], v[32:33]
    buffer_store_dwordx4 v[24:27], v22, s[44:47], s65 offen sc1
    s_branch L_W_done
L_W_qwg:
    s_cmp_lg_u32 s4, 0
    s_cbranch_scc1 L_W_done
    s_cmp_ge_u32 s5, 4
    s_cbranch_scc1 L_W_done
    v_and_b32 v21, 31, v0
    v_lshlrev_b32 v22, 4, v21
    v_lshrrev_b32 v23, 5, v0
    v_lshl_add_u32 v22, v23, 14, v22
    s_lshl_b32 s10, s5, 15
    s_lshl_b32 s11, s9, 9
    s_add_u32 s10, s10, s11
    s_add_u32 s66, s10, 524288
    s_add_u32 s67, s66, 4096
    s_add_u32 s68, s66, 8192
    s_add_u32 s69, s66, 12288
    s_lshl_b32 s10, s9, 8
    v_lshl_add_u32 v21, v21, 3, v2
    v_add_u32 v21, s10, v21
    v_lshlrev_b32 v44, 16, v96
    v_and_b32 v45, 0xffff0000, v96
    s_mov_b32 s13, 0x40000
Lw_90:
    ds_read_b32 v3, v2 offset:5168
    s_waitcnt lgkmcnt(0)
    v_readfirstlane_b32 s12, v3
    s_nop 0
    s_cmp_ge_u32 s12, 1
    s_cbranch_scc1 Lwd_91
    s_sub_u32 s13, s13, 1
    s_cbranch_scc1 Lwd_91
    s_cmp_eq_u32 s13, 261888
    s_cbranch_scc0 Le_92
    s_cmp_eq_u32 s96, 0
    s_cbranch_scc1 Lf_93
    ds_read_b32 v3, v2 offset:5180
    s_waitcnt lgkmcnt(0)
    v_readfirstlane_b32 s12, v3
    s_nop 0
    s_cmp_eq_u32 s12, 1
    s_cbranch_scc1 Lf_93
    s_mov_b32 exec_lo, 0x00ff0fff
    s_mov_b32 exec_hi, 0x00ff00ff
    buffer_store_dwordx4 v[100:103], v13, s[44:47], s97 offen sc1
    s_mov_b64 exec, -1
    s_mov_b32 s96, 0
Lf_93:
Le_92:
    s_sleep 1
    s_branch Lw_90
Lwd_91:
    s_mov_b32 s13, 0x3fff
Lp_94:
    buffer_load_dwordx4 v[24:27], v22, s[44:47], s66 offen offset:0 sc1
    buffer_load_dwordx4 v[28:31], v22, s[44:47], s67 offen offset:0 sc1
    buffer_load_dwordx4 v[32:35], v22, s[44:47], s68 offen offset:0 sc1
    buffer_load_dwordx4 v[36:39], v22, s[44:47], s69 offen offset:0 sc1
    s_waitcnt vmcnt(0)
    v_cmp_ne_u64 s[14:15], s[60:61], v[26:27]
    v_cmp_ne_u64 vcc, s[60:61], v[30:31]
    s_nop 0
    s_or_b64 s[14:15], s[14:15], vcc
    v_cmp_ne_u64 vcc, s[60:61], v[34:35]
    s_nop 0
    s_or_b64 s[14:15], s[14:15], vcc
    v_cmp_ne_u64 vcc, s[60:61], v[38:39]
    s_nop 0
    s_or_b64 s[14:15], s[14:15], vcc
    s_cmp_eq_u64 s[14:15], 0
    s_cbranch_scc1 Lpd_95
    s_sub_u32 s13, s13, 1
    s_cbranch_scc1 Lpd_95
    s_cmp_eq_u32 s13, 16375
    s_cbranch_scc0 Le_97
    s_cmp_eq_u32 s96, 0
    s_cbranch_scc1 Lf_98
    ds_read_b32 v3, v2 offset:5180
    s_waitcnt lgkmcnt(0)
    v_readfirstlane_b32 s12, v3
    s_nop 0
    s_cmp_eq_u32 s12, 1
    s_cbranch_scc1 Lf_98
    s_mov_b32 exec_lo, 0x00ff0fff
    s_mov_b32 exec_hi, 0x00ff00ff
    buffer_store_dwordx4 v[100:103], v13, s[44:47], s97 offen sc1
    s_mov_b64 exec, -1
    s_mov_b32 s96, 0
Lf_98:
Le_97:
    s_sleep 0
    s_branch Lp_94
Lpd_95:
    v_pk_add_f32 v[24:25], v[24:25], v[28:29]
    v_pk_add_f32 v[32:33], v[32:33], v[36:37]
    v_pk_add_f32 v[24:25], v[24:25], v[32:33]
    v_mov_b32 v26, v24
    v_mov_b32 v27, v25
    s_nop 0
    v_permlane32_swap_b32 v24, v26
    v_permlane32_swap_b32 v25, v27
    v_pk_add_f32 v[24:25], v[24:25], v[26:27]
    v_cvt_pk_bf16_f32 v26, v24, v25
    v_lshlrev_b32 v24, 16, v26
    v_and_b32 v25, 0xffff0000, v26
    v_pk_add_f32 v[24:25], v[24:25], v[44:45]
    v_cvt_pk_bf16_f32 v26, v24, v25
    v_lshlrev_b32 v24, 16, v26
    v_and_b32 v25, 0xffff0000, v26
    ds_write_b64 v21, v[24:25] offset:14336
    v_mov_b32 v3, 1
    s_mov_b64 exec, 1
    ds_add_u32 v2, v3 offset:5156
    s_mov_b64 exec, -1
L_W_done:
    s_cmp_eq_u32 s96, 0
    s_cbranch_scc1 Lf_99
    ds_read_b32 v3, v2 offset:5180
    s_waitcnt lgkmcnt(0)
    v_readfirstlane_b32 s12, v3
    s_nop 0
    s_cmp_eq_u32 s12, 1
    s_cbranch_scc1 Lf_99
    s_mov_b32 exec_lo, 0x00ff0fff
    s_mov_b32 exec_hi, 0x00ff00ff
    buffer_store_dwordx4 v[100:103], v13, s[44:47], s97 offen sc1
    s_mov_b64 exec, -1
    s_mov_b32 s96, 0
Lf_99:
L_end:
    s_endpgm
L_code_end:
.section .rodata,"a"
.p2align 6
.amdhsa_kernel sequential_preLN__sliding_block_cached__mixer_token_mlp__decode_kernel
  .amdhsa_next_free_vgpr 128
  .amdhsa_next_free_sgpr 102
  .amdhsa_accum_offset 128
  .amdhsa_group_segment_fixed_size 0
  .amdhsa_kernarg_size 104
  .amdhsa_user_sgpr_count 2
  .amdhsa_user_sgpr_kernarg_segment_ptr 1
  .amdhsa_system_sgpr_workgroup_id_x 1
  .amdhsa_float_denorm_mode_32 3
.end_amdhsa_kernel
```
